```python
import torch

def _softmax(x, axis=-1):
    return torch.softmax(x, dim=axis)
def _gelu(x):
    return torch.nn.functional.gelu(x, approximate="tanh")
def _silu(x):
    return torch.nn.functional.silu(x)
def _sigmoid(x):
    return torch.sigmoid(x)
def _layernorm(x, axis=-1, eps=1e-5):
    m = x.mean(dim=axis, keepdim=True)
    v = x.var(dim=axis, keepdim=True, unbiased=False)
    return (x - m) / torch.sqrt(v + eps)
def _scatter_add(tgt, idx, src, axis=0):
    return tgt.clone().index_add_(axis, idx, src)
def _segment_sum(src, seg, n):
    out = torch.zeros((n,) + src.shape[1:], dtype=src.dtype)
    return out.index_add_(0, seg, src)
def _pad(x, pw):
    flat = tuple(v for pair in reversed(pw) for v in pair)
    return torch.nn.functional.pad(x, flat)

kernel_name = 'sequential_preLN__gqa_block_cached__glu_gated_swiglu__decode'

def setup_inputs():

    _w = (lambda a: (lambda t: t.to(torch.bfloat16) if t.is_floating_point() else t)(torch.as_tensor(a)))
    def _A_setup():
        B, Sq, D = 1, 1, 512
        Hq, Hkv, Sk, Dh = 32, 8, 65536, 128
        assert Hq % Hkv == 0, (Hq, Hkv)
        return {
            "x": _w((lambda *s: torch.randn(*s, dtype=torch.bfloat16) * 0.05)(B, Sq, D)),
            "k_cache": _w((lambda *s: torch.randn(*s, dtype=torch.bfloat16) * 3.2)(B, Hkv, Sk, Dh)),
            "v_cache": _w((lambda *s: torch.randn(*s, dtype=torch.bfloat16) * 1.6)(B, Hkv, Sk, Dh)),
            "wq": _w((lambda *s: torch.randn(*s, dtype=torch.bfloat16) * 3.2)(D, Hq * Dh) * (D ** -0.5)),
            "wo": _w((lambda *s: torch.randn(*s, dtype=torch.bfloat16) * 1.6)(Hq * Dh, D) * ((Hq * Dh) ** -0.5)),
        }
    _A_in = _A_setup()

    def _B_setup():
        B, S, D, F = 1, 1, 512, 1792
        return {
            "x": _w((lambda *s: torch.randn(*s, dtype=torch.bfloat16) * 0.05)(B, S, D)),
            "w1": _w((lambda *s: torch.randn(*s, dtype=torch.bfloat16) * 1.6)(D, F) * (2.0 / D) ** 0.5),
            "w3": _w((lambda *s: torch.randn(*s, dtype=torch.bfloat16) * 1.6)(D, F) * (2.0 / D) ** 0.5),
            "w2": _w((lambda *s: torch.randn(*s, dtype=torch.bfloat16) * 1.6)(F, D) * (2.0 / F) ** 0.5),
        }
    _B_in = _B_setup()

    return {
        "A_x": _A_in["x"],
        "A_k_cache": _A_in["k_cache"],
        "A_v_cache": _A_in["v_cache"],
        "A_wq": _A_in["wq"],
        "A_wo": _A_in["wo"],
        "B_x": _B_in["x"],
        "B_w1": _B_in["w1"],
        "B_w3": _B_in["w3"],
        "B_w2": _B_in["w2"],
    }

def reference(A_x, A_k_cache, A_v_cache, A_wq, A_wo, B_x, B_w1, B_w3, B_w2):
    def _A_ref(x, k_cache, v_cache, wq, wo):
        B, Sq, D = x.shape
        Hq, Dh = 32, 128
        Hkv = k_cache.shape[1]
        rep = Hq // Hkv
        q = (lambda x, *d: x.permute(*d))((x @ wq).reshape(B, Sq, Hq, Dh), 0, 2, 1, 3)
        k = (lambda x, n, axis: torch.repeat_interleave(x, n, dim=axis))(k_cache, rep, axis=1)
        v = (lambda x, n, axis: torch.repeat_interleave(x, n, dim=axis))(v_cache, rep, axis=1)
        scores = torch.einsum("bhqd,bhkd->bhqk", q, k) * (Dh ** -0.5)
        p = _softmax(scores, axis=-1)
        o = torch.einsum("bhqk,bhkd->bhqd", p, v)
        return (lambda x, *d: x.permute(*d))(o, 0, 2, 1, 3).reshape(B, Sq, Hq * Dh) @ wo

    def _B_ref(x, w1, w3, w2):
        gate = torch.einsum("bsd,df->bsf", x, w1)
        up = torch.einsum("bsd,df->bsf", x, w3)
        h = _silu(gate) * up
        out = torch.einsum("bsf,fd->bsd", h, w2)
        return out

    x = A_x
    h = x + _A_ref(_layernorm(x, axis=-1), A_k_cache, A_v_cache, A_wq, A_wo)
    h2 = h + _B_ref(_layernorm(h, axis=-1), B_w1, B_w3, B_w2)
    return h2
```

```asm
; @launch grid=(256,1,1) block=(512,1,1) lds=163840
.amdgcn_target "amdgcn-amd-amdhsa--gfx950"
.text
.globl sequential_preLN__gqa_block_cached__glu_gated_swiglu__decode_kernel
.p2align 8
.type sequential_preLN__gqa_block_cached__glu_gated_swiglu__decode_kernel,@function
sequential_preLN__gqa_block_cached__glu_gated_swiglu__decode_kernel:
  s_cmp_ge_u32 s2, 256
  s_cbranch_scc1 L_end
  s_load_dwordx16 s[4:19], s[0:1], 0
  s_load_dwordx8 s[20:27], s[0:1], 64
  v_lshrrev_b32 v1, 6, v0
  v_and_b32 v0, 63, v0
  v_readfirstlane_b32 s3, v1
  s_cmp_lg_u32 s3, 5
  s_cbranch_scc1 L_nopf
  s_getpc_b64 s[40:41]
L_pc:
  s_sub_u32 s40, s40, L_pc-sequential_preLN__gqa_block_cached__glu_gated_swiglu__decode_kernel
  s_subb_u32 s41, s41, 0
  v_lshlrev_b32 v8, 7, v0
  v_min_u32 v9, L_end-sequential_preLN__gqa_block_cached__glu_gated_swiglu__decode_kernel-8192, v8
  global_load_dword v10, v8, s[40:41]
  s_add_u32 s40, s40, 8192
  s_addc_u32 s41, s41, 0
  global_load_dword v10, v9, s[40:41]
L_nopf:
  s_lshr_b32 s36, s2, 5
  s_and_b32 s37, s2, 31
  s_and_b32 s38, s2, 7
  s_lshl_b32 s38, s38, 2
  s_lshr_b32 s39, s37, 3
  s_add_u32 s38, s38, s39
  v_mov_b32 v1, 160896
  v_mov_b32 v4, 0
  v_mov_b32 v5, 0
  v_mov_b32 v6, 0
  v_mov_b32 v7, 0
  ds_write_b128 v1, v[4:7]
  s_cmp_lt_u32 s3, 4
  s_cbranch_scc1 L_stream
  v_mov_b32 v16, 0
  v_lshlrev_b32 v1, 4, v0
  s_lshl_b32 s40, s36, 10
  s_add_u32 s40, s40, 49152
  v_and_b32 v19, 7, v0
  v_lshl_add_u32 v19, v19, 7, s40
  s_waitcnt lgkmcnt(0)
  s_cmp_lg_u32 s3, 4
  s_cbranch_scc1 L_hbar
  s_cmp_lg_u32 s37, 31
  s_cbranch_scc1 L_hx
  global_store_dword v19, v16, s[26:27] sc1
L_hx:
  global_load_dwordx4 v[4:7], v1, s[4:5]
  global_load_dword v3, v16, s[26:27] sc1
L_hbar:
  s_barrier
  s_branch L_helper
L_stream:
  v_lshrrev_b32 v20, 4, v0
  v_and_b32 v21, 15, v0
  v_lshlrev_b32 v22, 1, v20
  v_xor_b32 v22, v22, v21
  v_lshlrev_b32 v22, 4, v22
  v_lshl_add_u32 v2, v20, 8, v22
  v_xor_b32 v3, 0x80, v2
  v_xor_b32 v4, 16, v2
  v_xor_b32 v5, 0x90, v2
  s_and_b32 s40, s2, 7
  s_lshl_b32 s41, s36, 3
  s_add_u32 s40, s40, s41
  s_lshl_b32 s40, s40, 21
  s_lshl_b32 s41, s39, 14
  s_add_u32 s40, s40, s41
  s_lshl_b32 s41, s3, 12
  s_add_u32 s40, s40, s41
  s_lshl_b32 s41, s3, 15
  s_mov_b32 s30, 0x8000000
  s_mov_b32 s31, 0x20000
  s_mov_b32 s34, 0x8000000
  s_mov_b32 s35, 0x20000
  s_mov_b32 s42, 0x2000
  s_mov_b32 s44, 4
  v_lshrrev_b32 v22, 3, v0
  v_and_b32 v23, 7, v0
  v_lshlrev_b32 v22, 13, v22
  v_lshl_add_u32 v22, v23, 4, v22
  s_lshl_b32 s47, s39, 20
  s_lshl_b32 s48, s3, 18
  s_add_u32 s47, s47, s48
  s_lshl_b32 s48, s36, 10
  s_add_u32 s47, s47, s48
  s_and_b32 s48, s2, 7
  s_lshl_b32 s48, s48, 7
  s_add_u32 s47, s47, s48
  s_lshl_b32 s48, s3, 12
  s_add_u32 m0, s48, 131072
  s_waitcnt lgkmcnt(0)
  s_add_u32 s48, s10, s47
  s_addc_u32 s49, s11, 0
  s_mov_b32 s28, s6
  global_load_lds_dwordx4 v22, s[48:49] nt
  v_add_u32 v22, 0x10000, v22
  s_add_u32 m0, m0, 1024
  s_nop 0
  global_load_lds_dwordx4 v22, s[48:49] nt
  v_add_u32 v22, 0x10000, v22
  s_add_u32 m0, m0, 1024
  s_nop 0
  global_load_lds_dwordx4 v22, s[48:49] nt
  v_add_u32 v22, 0x10000, v22
  s_add_u32 m0, m0, 1024
  s_nop 0
  global_load_lds_dwordx4 v22, s[48:49] nt
  s_and_b32 s29, s7, 0xffff
  s_add_u32 s32, s6, 0x10000
  s_addc_u32 s33, s29, 0
  s_mov_b32 s62, s40
  s_barrier
L_fill:
  s_mov_b32 m0, s41
  s_waitcnt vmcnt(5)
  buffer_load_dwordx4 v2, s[28:31], s40 offen offset:0 nt lds
  s_waitcnt vmcnt(5)
  buffer_load_dwordx4 v3, s[28:31], s40 offen offset:1024 nt lds
  s_waitcnt vmcnt(5)
  buffer_load_dwordx4 v4, s[28:31], s40 offen offset:2048 nt lds
  s_waitcnt vmcnt(5)
  buffer_load_dwordx4 v5, s[28:31], s40 offen offset:3072 nt lds
  s_add_u32 m0, s41, 4096
  s_waitcnt vmcnt(5)
  buffer_load_dwordx4 v2, s[32:35], s40 offen offset:0 nt lds
  s_waitcnt vmcnt(5)
  buffer_load_dwordx4 v3, s[32:35], s40 offen offset:1024 nt lds
  s_waitcnt vmcnt(5)
  buffer_load_dwordx4 v4, s[32:35], s40 offen offset:2048 nt lds
  s_waitcnt vmcnt(5)
  buffer_load_dwordx4 v5, s[32:35], s40 offen offset:3072 nt lds
  s_add_u32 s40, s40, 131072
  s_xor_b32 s41, s41, s42
  s_xor_b32 s42, s42, 0x4000
  s_cmp_lg_u32 s44, 4
  s_cbranch_scc1 L_nosig
  s_waitcnt vmcnt(8)
  v_mov_b32 v22, 1
  s_mov_b64 exec, 1
  ds_add_u32 v1, v22 offset:12
  s_mov_b64 exec, -1
L_nosig:
  s_sub_u32 s44, s44, 1
  s_cmp_lg_u32 s44, 0
  s_cbranch_scc1 L_fill
  s_lshl_b32 s46, s36, 24
  s_lshl_b32 s47, s3, 12
  s_add_u32 s46, s46, s47
  s_add_u32 s46, s46, 1835008
  s_lshl_b32 s57, s36, 2
  s_add_u32 s57, s57, s3
  s_lshl_b32 s57, s57, 8
  s_add_u32 s57, s57, 49152
  s_mov_b32 s58, 0
  s_lshl_b32 s47, s3, 15
  v_lshlrev_b32 v122, 9, v21
  v_lshl_add_u32 v122, v20, 4, v122
  v_add_u32 v122, s47, v122
  s_lshl_b32 s47, s3, 5
  s_add_u32 s47, s47, 160768
  v_lshl_add_u32 v123, v21, 3, s47
  v_lshlrev_b32 v124, 5, v0
  v_lshlrev_b32 v125, 3, v20
  v_add_u32 v125, 160768, v125
  s_lshl_b32 s47, s36, 15
  s_lshl_b32 s48, s38, 8
  s_add_u32 s47, s47, s48
  s_add_u32 s47, s47, 65536
  v_lshlrev_b32 v126, 13, v20
  v_lshl_add_u32 v126, v21, 4, v126
  v_add_u32 v126, s47, v126
  s_lshl_b32 s47, s36, 12
  s_lshl_b32 s48, s38, 7
  s_add_u32 s47, s47, s48
  s_add_u32 s47, s47, 983040
  v_lshl_add_u32 v127, v20, 4, s47
  v_mov_b32 v1, 160896
  v_mov_b32 v119, 1
  s_mov_b32 s43, 24
  v_lshlrev_b32 v23, 1, v21
  v_and_b32 v23, 15, v23
  v_lshrrev_b32 v24, 3, v21
  v_or_b32 v23, v23, v24
  v_and_b32 v24, 1, v20
  v_lshlrev_b32 v24, 1, v24
  v_lshrrev_b32 v25, 1, v20
  v_or_b32 v24, v24, v25
  v_xor_b32 v23, v23, v24
  v_lshlrev_b32 v23, 4, v23
  v_lshl_add_u32 v23, v21, 8, v23
  v_add_u32 v6, s41, v23
  v_xor_b32 v7, 64, v6
  v_xor_b32 v8, 128, v6
  v_xor_b32 v9, 192, v6
  v_lshrrev_b32 v25, 2, v0
  v_lshlrev_b32 v26, 1, v25
  v_and_b32 v26, 15, v26
  v_lshrrev_b32 v27, 3, v25
  v_or_b32 v26, v26, v27
  v_bfe_u32 v27, v0, 1, 1
  v_xor_b32 v26, v26, v27
  v_lshlrev_b32 v26, 4, v26
  v_lshl_add_u32 v26, v25, 8, v26
  v_and_b32 v27, 1, v0
  v_lshl_add_u32 v26, v27, 3, v26
  v_add_u32 v10, s41, v26
  v_xor_b32 v11, 32, v10
  v_xor_b32 v12, 64, v10
  v_xor_b32 v13, 96, v10
  v_xor_b32 v14, 128, v10
  v_xor_b32 v15, 160, v10
  v_xor_b32 v16, 192, v10
  v_xor_b32 v17, 224, v10
  v_and_b32 v25, 3, v21
  v_lshlrev_b32 v25, 8, v25
  v_lshl_add_u32 v25, v24, 4, v25
  v_add_u32 v108, 159744, v25
  v_and_b32 v23, 3, v21
  v_lshlrev_b32 v23, 5, v23
  v_lshl_add_u32 v23, v20, 3, v23
  s_mul_i32 s47, s3, 5120
  s_add_u32 s47, s47, 131072
  v_add_u32 v23, s47, v23
  s_mov_b32 s47, 0
  s_lshr_b32 s48, s2, 3
  s_lshl_b32 s48, s48, 2
  s_add_u32 s48, s48, s3
  s_and_b32 s49, s2, 7
  s_min_u32 s49, s49, 6
  v_bfe_u32 v25, v0, 2, 2
  v_mul_u32_u24 v25, 3584, v25
  v_and_b32 v26, 3, v0
  v_lshl_add_u32 v25, v26, 7, v25
  s_mul_i32 s50, s48, 14336
  s_lshl_b32 s47, s49, 9
  s_add_u32 s50, s50, s47
  v_add_u32 v25, s50, v25
  s_lshl_b32 s50, s49, 18
  s_lshl_b32 s47, s48, 11
  s_add_u32 s50, s50, s47
  v_lshl_add_u32 v26, v21, 7, s50
  v_cmp_gt_u32 vcc, 2, v20
  v_cmp_eq_u32 s[48:49], 1, v20
  v_mov_b32 v27, 0
  v_cndmask_b32 v26, v26, v25, vcc
  v_mov_b32 v28, s16
  v_mov_b32 v29, s17
  v_mov_b32 v30, s18
  v_mov_b32 v31, s19
  v_cndmask_b32 v28, v28, v30, s[48:49]
  v_cndmask_b32 v29, v29, v31, s[48:49]
  v_mov_b32 v30, s20
  v_mov_b32 v31, s21
  v_cndmask_b32 v28, v30, v28, vcc
  v_cndmask_b32 v29, v31, v29, vcc
  v_lshl_add_u64 v[20:21], v[26:27], 0, v[28:29]
  s_mov_b32 s47, 0
  v_mov_b32 v18, 0xff7fffff
  v_mov_b32 v19, 0x7f7fffff
  v_mov_b32 v109, 0
  v_mov_b32 v76, 0
  v_mov_b32 v77, 0
  v_mov_b32 v78, 0
  v_mov_b32 v79, 0
  v_mov_b32 v80, 0
  v_mov_b32 v81, 0
  v_mov_b32 v82, 0
  v_mov_b32 v83, 0
  v_mov_b32 v84, 0
  v_mov_b32 v85, 0
  v_mov_b32 v86, 0
  v_mov_b32 v87, 0
  v_mov_b32 v88, 0
  v_mov_b32 v89, 0
  v_mov_b32 v90, 0
  v_mov_b32 v91, 0
  v_mov_b32 v92, 0
  v_mov_b32 v93, 0
  v_mov_b32 v94, 0
  v_mov_b32 v95, 0
  v_mov_b32 v96, 0
  v_mov_b32 v97, 0
  v_mov_b32 v98, 0
  v_mov_b32 v99, 0
  v_mov_b32 v100, 0
  v_mov_b32 v101, 0
  v_mov_b32 v102, 0
  v_mov_b32 v103, 0
  v_mov_b32 v104, 0
  v_mov_b32 v105, 0
  v_mov_b32 v106, 0
  v_mov_b32 v107, 0
  s_mov_b32 s45, 1069066811
  s_mov_b32 s44, 4
  s_mov_b32 s54, 0x2000
  s_mov_b32 s55, 4
  v_mov_b32 v116, 160904
  s_mul_i32 s39, s39, 1
  s_mul_i32 s52, s3, 1
  s_add_u32 s39, s39, s52
  s_mov_b32 s52, 0
  s_mul_i32 s53, s3, 0
  s_add_u32 s53, s53, 2
  ds_read_b32 v117, v116
  s_waitcnt lgkmcnt(0)
  v_readfirstlane_b32 s48, v117
  s_cmp_lg_u32 s48, 0
  s_cbranch_scc1 L_qok
  s_waitcnt vmcnt(5)
  buffer_load_dwordx4 v[128:131], v2, s[28:31], s40 offen offset:0 nt
  s_waitcnt vmcnt(5)
  buffer_load_dwordx4 v[132:135], v3, s[28:31], s40 offen offset:1024 nt
  s_waitcnt vmcnt(5)
  buffer_load_dwordx4 v[136:139], v4, s[28:31], s40 offen offset:2048 nt
  s_waitcnt vmcnt(5)
  buffer_load_dwordx4 v[140:143], v5, s[28:31], s40 offen offset:3072 nt
  s_waitcnt vmcnt(5)
  buffer_load_dwordx4 v[144:147], v2, s[32:35], s40 offen offset:0 nt
  s_waitcnt vmcnt(5)
  buffer_load_dwordx4 v[148:151], v3, s[32:35], s40 offen offset:1024 nt
  s_waitcnt vmcnt(5)
  buffer_load_dwordx4 v[152:155], v4, s[32:35], s40 offen offset:2048 nt
  s_waitcnt vmcnt(5)
  buffer_load_dwordx4 v[156:159], v5, s[32:35], s40 offen offset:3072 nt
  s_add_u32 s40, s40, 131072
  s_add_u32 s52, s52, 1
  s_sub_u32 s43, s43, 1
  ds_read_b32 v117, v116
  s_waitcnt lgkmcnt(0)
  v_readfirstlane_b32 s48, v117
  s_cmp_lg_u32 s48, 0
  s_cbranch_scc1 L_qok
  s_waitcnt vmcnt(5)
  buffer_load_dwordx4 v[160:163], v2, s[28:31], s40 offen offset:0 nt
  s_waitcnt vmcnt(5)
  buffer_load_dwordx4 v[164:167], v3, s[28:31], s40 offen offset:1024 nt
  s_waitcnt vmcnt(5)
  buffer_load_dwordx4 v[168:171], v4, s[28:31], s40 offen offset:2048 nt
  s_waitcnt vmcnt(5)
  buffer_load_dwordx4 v[172:175], v5, s[28:31], s40 offen offset:3072 nt
  s_waitcnt vmcnt(5)
  buffer_load_dwordx4 v[176:179], v2, s[32:35], s40 offen offset:0 nt
  s_waitcnt vmcnt(5)
  buffer_load_dwordx4 v[180:183], v3, s[32:35], s40 offen offset:1024 nt
  s_waitcnt vmcnt(5)
  buffer_load_dwordx4 v[184:187], v4, s[32:35], s40 offen offset:2048 nt
  s_waitcnt vmcnt(5)
  buffer_load_dwordx4 v[188:191], v5, s[32:35], s40 offen offset:3072 nt
  s_add_u32 s40, s40, 131072
  s_add_u32 s52, s52, 1
  s_sub_u32 s43, s43, 1
  ds_read_b32 v117, v116
  s_waitcnt lgkmcnt(0)
  v_readfirstlane_b32 s48, v117
  s_cmp_lg_u32 s48, 0
  s_cbranch_scc1 L_qok
  s_waitcnt vmcnt(5)
  buffer_load_dwordx4 v[192:195], v2, s[28:31], s40 offen offset:0 nt
  s_waitcnt vmcnt(5)
  buffer_load_dwordx4 v[196:199], v3, s[28:31], s40 offen offset:1024 nt
  s_waitcnt vmcnt(5)
  buffer_load_dwordx4 v[200:203], v4, s[28:31], s40 offen offset:2048 nt
  s_waitcnt vmcnt(5)
  buffer_load_dwordx4 v[204:207], v5, s[28:31], s40 offen offset:3072 nt
  s_waitcnt vmcnt(5)
  buffer_load_dwordx4 v[208:211], v2, s[32:35], s40 offen offset:0 nt
  s_waitcnt vmcnt(5)
  buffer_load_dwordx4 v[212:215], v3, s[32:35], s40 offen offset:1024 nt
  s_waitcnt vmcnt(5)
  buffer_load_dwordx4 v[216:219], v4, s[32:35], s40 offen offset:2048 nt
  s_waitcnt vmcnt(5)
  buffer_load_dwordx4 v[220:223], v5, s[32:35], s40 offen offset:3072 nt
  s_add_u32 s40, s40, 131072
  s_add_u32 s52, s52, 1
  s_sub_u32 s43, s43, 1
  ds_read_b32 v117, v116
  s_waitcnt lgkmcnt(0)
  v_readfirstlane_b32 s48, v117
  s_cmp_lg_u32 s48, 0
  s_cbranch_scc1 L_qok
  s_waitcnt vmcnt(5)
  buffer_load_dwordx4 v[224:227], v2, s[28:31], s40 offen offset:0 nt
  s_waitcnt vmcnt(5)
  buffer_load_dwordx4 v[228:231], v3, s[28:31], s40 offen offset:1024 nt
  s_waitcnt vmcnt(5)
  buffer_load_dwordx4 v[232:235], v4, s[28:31], s40 offen offset:2048 nt
  s_waitcnt vmcnt(5)
  buffer_load_dwordx4 v[236:239], v5, s[28:31], s40 offen offset:3072 nt
  s_waitcnt vmcnt(5)
  buffer_load_dwordx4 v[240:243], v2, s[32:35], s40 offen offset:0 nt
  s_waitcnt vmcnt(5)
  buffer_load_dwordx4 v[244:247], v3, s[32:35], s40 offen offset:1024 nt
  s_waitcnt vmcnt(5)
  buffer_load_dwordx4 v[248:251], v4, s[32:35], s40 offen offset:2048 nt
  s_waitcnt vmcnt(5)
  buffer_load_dwordx4 v[252:255], v5, s[32:35], s40 offen offset:3072 nt
  s_add_u32 s40, s40, 131072
  s_add_u32 s52, s52, 1
  s_sub_u32 s43, s43, 1
L_qwait:
  ds_read_b32 v117, v116
  s_waitcnt lgkmcnt(0)
  v_readfirstlane_b32 s48, v117
  s_cmp_lg_u32 s48, 0
  s_cbranch_scc1 L_qok
  s_sleep 1
  s_branch L_qwait
L_qok:
  s_add_u32 s56, s52, 4
  ds_read_b32 v22, v1 offset:16
  ds_read_b128 v[24:27], v108 offset:0
  ds_read_b128 v[28:31], v108 offset:64
  ds_read_b128 v[32:35], v108 offset:128
  ds_read_b128 v[36:39], v108 offset:192
L_tile:
  s_waitcnt vmcnt(24)
  s_cmp_gt_u32 s44, 3
  s_cbranch_scc1 L_go
  s_waitcnt vmcnt(16)
  s_cmp_gt_u32 s44, 2
  s_cbranch_scc1 L_go
  s_waitcnt vmcnt(8)
  s_cmp_gt_u32 s44, 1
  s_cbranch_scc1 L_go
  s_cmp_ge_u32 s47, 28
  s_cbranch_scc1 L_last
  s_waitcnt vmcnt(0)
  s_branch L_go
L_last:
  s_waitcnt vmcnt(4)
  ds_read_b128 v[40:43], v6
  ds_read_b128 v[44:47], v7
  ds_read_b128 v[48:51], v8
  ds_read_b128 v[52:55], v9
  s_waitcnt lgkmcnt(3)
  v_mfma_f32_16x16x32_bf16 v[72:75], v[40:43], v[24:27], 0
  s_waitcnt lgkmcnt(2)
  v_mfma_f32_16x16x32_bf16 v[72:75], v[44:47], v[28:31], v[72:75]
  s_waitcnt lgkmcnt(1)
  v_mfma_f32_16x16x32_bf16 v[72:75], v[48:51], v[32:35], v[72:75]
  s_waitcnt lgkmcnt(0)
  v_mfma_f32_16x16x32_bf16 v[72:75], v[52:55], v[36:39], v[72:75]
  s_branch L_sm
L_go:
  s_mov_b32 s63, s47
  s_add_u32 s47, s47, 1
  s_cmp_eq_u32 s47, 4
  s_cselect_b32 s47, s56, s47
  s_cmp_lt_u32 s63, 14
  s_cbranch_scc1 L_kk
  s_sub_u32 s48, s63, 14
  s_cmp_lt_u32 s63, 28
  s_cbranch_scc1 L_vv
  ds_read_b128 v[40:43], v6
  ds_read_b128 v[44:47], v7
  ds_read_b128 v[48:51], v8
  ds_read_b128 v[52:55], v9
  ds_read_b64_tr_b16 v[56:57], v10 offset:4096
  ds_read_b64_tr_b16 v[58:59], v11 offset:4096
  ds_read_b64_tr_b16 v[60:61], v12 offset:4096
  ds_read_b64_tr_b16 v[62:63], v13 offset:4096
  ds_read_b64_tr_b16 v[64:65], v14 offset:4096
  ds_read_b64_tr_b16 v[66:67], v15 offset:4096
  ds_read_b64_tr_b16 v[68:69], v16 offset:4096
  ds_read_b64_tr_b16 v[70:71], v17 offset:4096
  s_waitcnt lgkmcnt(11)
  v_mfma_f32_16x16x32_bf16 v[72:75], v[40:43], v[24:27], 0
  s_waitcnt lgkmcnt(10)
  v_mfma_f32_16x16x32_bf16 v[72:75], v[44:47], v[28:31], v[72:75]
  s_waitcnt lgkmcnt(9)
  v_mfma_f32_16x16x32_bf16 v[72:75], v[48:51], v[32:35], v[72:75]
  s_waitcnt lgkmcnt(8)
  v_mfma_f32_16x16x32_bf16 v[72:75], v[52:55], v[36:39], v[72:75]
L_sm:
  v_xor_b32 v6, s54, v6
  v_xor_b32 v7, s54, v7
  v_xor_b32 v8, s54, v8
  v_xor_b32 v9, s54, v9
  v_xor_b32 v10, s54, v10
  v_xor_b32 v11, s54, v11
  v_xor_b32 v12, s54, v12
  v_xor_b32 v13, s54, v13
  v_xor_b32 v14, s54, v14
  v_xor_b32 v15, s54, v15
  v_xor_b32 v16, s54, v16
  v_xor_b32 v17, s54, v17
  v_cvt_pk_bf16_f32 v110, v72, v73
  v_cvt_pk_bf16_f32 v111, v74, v75
  v_lshlrev_b32 v112, 16, v110
  v_and_b32 v113, 0xffff0000, v110
  v_lshlrev_b32 v114, 16, v111
  v_and_b32 v115, 0xffff0000, v111
  v_mul_f32 v112, 0x3db504f3, v112
  v_mul_f32 v113, 0x3db504f3, v113
  v_mul_f32 v114, 0x3db504f3, v114
  v_mul_f32 v115, 0x3db504f3, v115
  v_cvt_pk_bf16_f32 v110, v112, v113
  v_cvt_pk_bf16_f32 v111, v114, v115
  v_lshlrev_b32 v112, 16, v110
  v_and_b32 v113, 0xffff0000, v110
  v_lshlrev_b32 v114, 16, v111
  v_and_b32 v115, 0xffff0000, v111
  v_max3_f32 v116, v112, v113, v114
  v_max_f32 v117, v115, v18
  v_fma_f32 v72, v112, s45, v19
  v_fma_f32 v73, v113, s45, v19
  v_fma_f32 v74, v114, s45, v19
  v_fma_f32 v75, v115, s45, v19
  v_max_f32 v110, v116, v117
  v_max_f32 v111, v116, v117
  v_cmp_gt_f32 vcc, v110, v18
  v_mov_b32 v118, 1.0
  s_cbranch_vccnz L_newmax
  v_exp_f32 v112, v72
  v_exp_f32 v113, v73
  v_exp_f32 v114, v74
  v_exp_f32 v115, v75
  s_nop 0
L_nors:
  v_add_f32 v116, v112, v113
  v_add_f32 v117, v114, v115
  v_cvt_pk_bf16_f32 v120, v112, v113
  v_cvt_pk_bf16_f32 v121, v114, v115
  v_add_f32 v116, v116, v117
  v_fma_f32 v109, v109, v118, v116
  s_cmp_gt_u32 s44, 1
  s_cbranch_scc1 L_pv
  v_xor_b32 v10, s54, v10
  v_xor_b32 v11, s54, v11
  v_xor_b32 v12, s54, v12
  v_xor_b32 v13, s54, v13
  v_xor_b32 v14, s54, v14
  v_xor_b32 v15, s54, v15
  v_xor_b32 v16, s54, v16
  v_xor_b32 v17, s54, v17
  s_waitcnt vmcnt(0)
  ds_read_b64_tr_b16 v[56:57], v10 offset:4096
  ds_read_b64_tr_b16 v[58:59], v11 offset:4096
  ds_read_b64_tr_b16 v[60:61], v12 offset:4096
  ds_read_b64_tr_b16 v[62:63], v13 offset:4096
  ds_read_b64_tr_b16 v[64:65], v14 offset:4096
  ds_read_b64_tr_b16 v[66:67], v15 offset:4096
  ds_read_b64_tr_b16 v[68:69], v16 offset:4096
  ds_read_b64_tr_b16 v[70:71], v17 offset:4096
  s_waitcnt lgkmcnt(7)
  v_mfma_f32_16x16x16_bf16 v[76:79], v[56:57], v[120:121], v[76:79]
  s_waitcnt lgkmcnt(6)
  v_mfma_f32_16x16x16_bf16 v[80:83], v[58:59], v[120:121], v[80:83]
  s_waitcnt lgkmcnt(5)
  v_mfma_f32_16x16x16_bf16 v[84:87], v[60:61], v[120:121], v[84:87]
  s_waitcnt lgkmcnt(4)
  v_mfma_f32_16x16x16_bf16 v[88:91], v[62:63], v[120:121], v[88:91]
  s_waitcnt lgkmcnt(3)
  v_mfma_f32_16x16x16_bf16 v[92:95], v[64:65], v[120:121], v[92:95]
  s_waitcnt lgkmcnt(2)
  v_mfma_f32_16x16x16_bf16 v[96:99], v[66:67], v[120:121], v[96:99]
  s_waitcnt lgkmcnt(1)
  v_mfma_f32_16x16x16_bf16 v[100:103], v[68:69], v[120:121], v[100:103]
  s_waitcnt lgkmcnt(0)
  v_mfma_f32_16x16x16_bf16 v[104:107], v[70:71], v[120:121], v[104:107]
  s_branch L_fin
L_pv:
  s_waitcnt lgkmcnt(0)
  v_mfma_f32_16x16x16_bf16 v[76:79], v[56:57], v[120:121], v[76:79]
  v_mfma_f32_16x16x16_bf16 v[80:83], v[58:59], v[120:121], v[80:83]
  v_mfma_f32_16x16x16_bf16 v[84:87], v[60:61], v[120:121], v[84:87]
  v_mfma_f32_16x16x16_bf16 v[88:91], v[62:63], v[120:121], v[88:91]
  v_mfma_f32_16x16x16_bf16 v[92:95], v[64:65], v[120:121], v[92:95]
  v_mfma_f32_16x16x16_bf16 v[96:99], v[66:67], v[120:121], v[96:99]
  v_mfma_f32_16x16x16_bf16 v[100:103], v[68:69], v[120:121], v[100:103]
  v_mfma_f32_16x16x16_bf16 v[104:107], v[70:71], v[120:121], v[104:107]
L_skipc:
  s_cmp_eq_u32 s52, 0
  s_cbranch_scc1 L_nopark
  s_cmp_ge_u32 s47, 14
  s_cbranch_scc1 L_park
  s_sub_u32 s53, s53, 1
  s_cmp_lg_u32 s53, 0
  s_cbranch_scc1 L_nopark
L_park:
  s_mov_b32 s53, 3
  s_sub_u32 s52, s52, 1
  v_lshl_add_u32 v116, v0, 4, s41
  s_waitcnt vmcnt(8)
  s_cmp_lg_u32 s52, 0
  s_cbranch_scc1 L_pk0
  ds_write_b128 v116, v[128:131] offset:0
  ds_write_b128 v116, v[132:135] offset:1024
  ds_write_b128 v116, v[136:139] offset:2048
  ds_write_b128 v116, v[140:143] offset:3072
  ds_write_b128 v116, v[144:147] offset:4096
  ds_write_b128 v116, v[148:151] offset:5120
  ds_write_b128 v116, v[152:155] offset:6144
  ds_write_b128 v116, v[156:159] offset:7168
  s_branch L_pkd
L_pk0:
  s_cmp_lg_u32 s52, 1
  s_cbranch_scc1 L_pk1
  ds_write_b128 v116, v[160:163] offset:0
  ds_write_b128 v116, v[164:167] offset:1024
  ds_write_b128 v116, v[168:171] offset:2048
  ds_write_b128 v116, v[172:175] offset:3072
  ds_write_b128 v116, v[176:179] offset:4096
  ds_write_b128 v116, v[180:183] offset:5120
  ds_write_b128 v116, v[184:187] offset:6144
  ds_write_b128 v116, v[188:191] offset:7168
  s_branch L_pkd
L_pk1:
  s_cmp_lg_u32 s52, 2
  s_cbranch_scc1 L_pk2
  ds_write_b128 v116, v[192:195] offset:0
  ds_write_b128 v116, v[196:199] offset:1024
  ds_write_b128 v116, v[200:203] offset:2048
  ds_write_b128 v116, v[204:207] offset:3072
  ds_write_b128 v116, v[208:211] offset:4096
  ds_write_b128 v116, v[212:215] offset:5120
  ds_write_b128 v116, v[216:219] offset:6144
  ds_write_b128 v116, v[220:223] offset:7168
  s_branch L_pkd
L_pk2:
  ds_write_b128 v116, v[224:227] offset:0
  ds_write_b128 v116, v[228:231] offset:1024
  ds_write_b128 v116, v[232:235] offset:2048
  ds_write_b128 v116, v[236:239] offset:3072
  ds_write_b128 v116, v[240:243] offset:4096
  ds_write_b128 v116, v[244:247] offset:5120
  ds_write_b128 v116, v[248:251] offset:6144
  ds_write_b128 v116, v[252:255] offset:7168
L_pkd:
  v_xor_b32 v6, s54, v6
  v_xor_b32 v7, s54, v7
  v_xor_b32 v8, s54, v8
  v_xor_b32 v9, s54, v9
  v_xor_b32 v10, s54, v10
  v_xor_b32 v11, s54, v11
  v_xor_b32 v12, s54, v12
  v_xor_b32 v13, s54, v13
  v_xor_b32 v14, s54, v14
  v_xor_b32 v15, s54, v15
  v_xor_b32 v16, s54, v16
  v_xor_b32 v17, s54, v17
  s_add_u32 s63, s52, 4
  s_branch L_kk
L_nopark:
  s_xor_b32 s54, s54, 0x4000
  s_add_u32 s39, s39, 1
  s_cmp_lt_u32 s39, 16
  s_cbranch_scc1 L_keep
  s_cmp_lg_u32 s52, 0
  s_cbranch_scc1 L_keep
  s_cmp_lt_u32 s39, 22
  s_cselect_b32 s48, 3, 2
  s_min_u32 s55, s55, s48
  s_cmp_gt_u32 s44, s55
  s_cbranch_scc1 L_drain
L_keep:
  s_cmp_eq_u32 s43, 0
  s_cbranch_scc1 L_dyn
  s_cmp_lg_u32 s43, 14
  s_cbranch_scc1 L_nosw
  s_mov_b32 s28, s8
  s_and_b32 s29, s9, 0xffff
  s_add_u32 s32, s8, 0x10000
  s_addc_u32 s33, s29, 0
  s_mov_b32 s40, s62
L_nosw:
  s_sub_u32 s43, s43, 1
  s_branch L_issue
L_dyn:
  s_mov_b32 s28, s6
  s_and_b32 s29, s7, 0xffff
  s_mov_b32 s32, s8
  s_and_b32 s33, s9, 0xffff
  s_cmp_ge_u32 s58, 128
  s_cbranch_scc1 L_empty
  s_and_b32 s49, s58, 7
  s_lshr_b32 s50, s58, 3
  s_lshl_b32 s49, s49, 21
  s_lshl_b32 s50, s50, 14
  s_add_u32 s40, s46, s49
  s_add_u32 s40, s40, s50
  s_cmp_lt_u32 s58, 104
  s_cbranch_scc1 L_issue
  s_cmp_ge_u32 s58, 112
  s_cselect_b32 s43, 1, 0
  s_cselect_b32 s58, 128, s58
  s_mov_b32 m0, s41
  s_waitcnt vmcnt(15)
  buffer_load_dwordx4 v2, s[28:31], s40 offen offset:0 nt lds
  s_waitcnt vmcnt(15)
  buffer_load_dwordx4 v3, s[28:31], s40 offen offset:1024 nt lds
  s_waitcnt vmcnt(15)
  buffer_load_dwordx4 v4, s[28:31], s40 offen offset:2048 nt lds
  s_waitcnt vmcnt(15)
  buffer_load_dwordx4 v5, s[28:31], s40 offen offset:3072 nt lds
  s_add_u32 m0, s41, 4096
  s_waitcnt vmcnt(15)
  buffer_load_dwordx4 v2, s[32:35], s40 offen offset:0 nt lds
  s_cmp_lg_u32 s43, 0
  s_cbranch_scc1 L_notk2
  s_mov_b32 s58, 1
  s_atomic_add s58, s[26:27], s57 glc
L_notk2:
  s_waitcnt vmcnt(15)
  buffer_load_dwordx4 v3, s[32:35], s40 offen offset:1024 nt lds
  s_waitcnt vmcnt(15)
  buffer_load_dwordx4 v4, s[32:35], s40 offen offset:2048 nt lds
  s_waitcnt vmcnt(15)
  buffer_load_dwordx4 v5, s[32:35], s40 offen offset:3072 nt lds
  s_add_u32 s40, s40, 131072
  s_mov_b32 s43, 0
  s_branch L_issued
L_issue:
  s_mov_b32 m0, s41
  s_waitcnt vmcnt(6)
  buffer_load_dwordx4 v2, s[28:31], s40 offen offset:0 nt lds
  s_waitcnt vmcnt(6)
  buffer_load_dwordx4 v3, s[28:31], s40 offen offset:1024 nt lds
  s_waitcnt vmcnt(6)
  buffer_load_dwordx4 v4, s[28:31], s40 offen offset:2048 nt lds
  s_waitcnt vmcnt(6)
  buffer_load_dwordx4 v5, s[28:31], s40 offen offset:3072 nt lds
  s_add_u32 m0, s41, 4096
  s_waitcnt vmcnt(6)
  buffer_load_dwordx4 v2, s[32:35], s40 offen offset:0 nt lds
  s_cmp_lg_u32 s43, 0
  s_cbranch_scc1 L_notk1
  s_mov_b32 s58, 1
  s_atomic_add s58, s[26:27], s57 glc
L_notk1:
  s_waitcnt vmcnt(6)
  buffer_load_dwordx4 v3, s[32:35], s40 offen offset:1024 nt lds
  s_waitcnt vmcnt(6)
  buffer_load_dwordx4 v4, s[32:35], s40 offen offset:2048 nt lds
  s_waitcnt vmcnt(6)
  buffer_load_dwordx4 v5, s[32:35], s40 offen offset:3072 nt lds
  s_add_u32 s40, s40, 131072
L_issued:
  s_xor_b32 s41, s41, s42
  s_xor_b32 s42, s42, 0x4000
  s_branch L_tile
L_empty:
  s_cmp_eq_u32 s52, 0
  s_cbranch_scc1 L_empty2
  s_xor_b32 s54, s54, 0x4000
  s_branch L_park
L_empty2:
  ds_write_b32 v1, v119 offset:4
  s_mov_b32 s55, 0
L_drain:
  s_sub_u32 s44, s44, 1
  s_cmp_lg_u32 s44, 0
  s_cbranch_scc1 L_tile
L_fin:
  s_lshr_b32 s48, s2, 3
  s_lshl_b32 s48, s48, 2
  s_add_u32 s48, s48, s3
  s_lshr_b32 s49, s48, 4
  s_lshl_b32 s49, s49, 16
  s_and_b32 s48, s48, 15
  s_lshl_b32 s48, s48, 11
  s_add_u32 s48, s48, s49
  s_and_b32 s49, s2, 7
  s_lshl_b32 s49, s49, 19
  s_add_u32 s48, s48, s49
  s_add_u32 s48, s48, 0x8000
  v_and_b32 v146, 31, v0
  v_lshl_add_u32 v146, v146, 6, s48
  global_load_dword v147, v146, s[12:13]
  s_and_b32 s48, s2, 7
  s_cmp_eq_u32 s48, 7
  s_cbranch_scc1 L_nopff
  global_load_dword v144, v[20:21], off
  global_load_dword v145, v[20:21], off offset:64
L_nopff:
  v_mov_b32 v116, v109
  v_mov_b32 v108, v19
  s_nop 0
  v_permlane16_swap_b32 v109, v116
  v_add_f32 v117, v109, v116
  v_add_f32 v109, v109, v116
  s_mov_b32 exec_lo, 0x000f000f
  s_mov_b32 exec_hi, 0x000f000f
  ds_write_b128 v122, v[76:79] offset:0
  ds_write_b128 v122, v[80:83] offset:64
  ds_write_b128 v122, v[84:87] offset:128
  ds_write_b128 v122, v[88:91] offset:192
  ds_write_b128 v122, v[92:95] offset:256
  ds_write_b128 v122, v[96:99] offset:320
  ds_write_b128 v122, v[100:103] offset:384
  ds_write_b128 v122, v[104:107] offset:448
  s_mov_b64 exec, -1
  v_permlane32_swap_b32 v109, v117
  v_add_f32 v109, v109, v117
  s_mov_b64 exec, 15
  ds_write_b64 v123, v[108:109]
  s_mov_b64 exec, 1
  ds_add_rtn_u32 v111, v1, v119
  s_mov_b64 exec, -1
  s_waitcnt lgkmcnt(0)
  v_readfirstlane_b32 s44, v111
  s_cmp_eq_u32 s44, 3
  s_cbranch_scc0 L_sdone
  v_mov_b32 v33, v22
  v_mov_b32 v35, v22
  ds_read_b64 v[24:25], v125 offset:0
  ds_read_b64 v[26:27], v125 offset:32
  ds_read_b64 v[28:29], v125 offset:64
  ds_read_b64 v[30:31], v125 offset:96
  ds_read_b128 v[40:43], v124 offset:0
  ds_read_b128 v[44:47], v124 offset:16
  ds_read_b128 v[48:51], v124 offset:32768
  ds_read_b128 v[52:55], v124 offset:32784
  v_add_u32 v124, 0x10000, v124
  ds_read_b128 v[56:59], v124 offset:0
  ds_read_b128 v[60:63], v124 offset:16
  ds_read_b128 v[64:67], v124 offset:32768
  ds_read_b128 v[68:71], v124 offset:32784
  s_waitcnt lgkmcnt(8)
  v_min3_f32 v32, v24, v26, v28
  v_min_f32 v32, v32, v30
  v_sub_f32 v24, v32, v24
  v_sub_f32 v26, v32, v26
  v_sub_f32 v28, v32, v28
  v_sub_f32 v30, v32, v30
  v_exp_f32 v24, v24
  v_exp_f32 v26, v26
  v_exp_f32 v28, v28
  v_exp_f32 v30, v30
  s_waitcnt lgkmcnt(6)
  v_pk_mul_f32 v[40:41], v[40:41], v[24:25] op_sel_hi:[1,0]
  v_pk_mul_f32 v[42:43], v[42:43], v[24:25] op_sel_hi:[1,0]
  v_pk_mul_f32 v[44:45], v[44:45], v[24:25] op_sel_hi:[1,0]
  v_pk_mul_f32 v[46:47], v[46:47], v[24:25] op_sel_hi:[1,0]
  s_waitcnt lgkmcnt(4)
  v_pk_fma_f32 v[40:41], v[48:49], v[26:27], v[40:41] op_sel_hi:[1,0,1]
  v_pk_fma_f32 v[42:43], v[50:51], v[26:27], v[42:43] op_sel_hi:[1,0,1]
  v_pk_fma_f32 v[44:45], v[52:53], v[26:27], v[44:45] op_sel_hi:[1,0,1]
  v_pk_fma_f32 v[46:47], v[54:55], v[26:27], v[46:47] op_sel_hi:[1,0,1]
  s_waitcnt lgkmcnt(2)
  v_pk_fma_f32 v[40:41], v[56:57], v[28:29], v[40:41] op_sel_hi:[1,0,1]
  v_pk_fma_f32 v[42:43], v[58:59], v[28:29], v[42:43] op_sel_hi:[1,0,1]
  v_pk_fma_f32 v[44:45], v[60:61], v[28:29], v[44:45] op_sel_hi:[1,0,1]
  v_pk_fma_f32 v[46:47], v[62:63], v[28:29], v[46:47] op_sel_hi:[1,0,1]
  s_waitcnt lgkmcnt(0)
  v_pk_fma_f32 v[40:41], v[64:65], v[30:31], v[40:41] op_sel_hi:[1,0,1]
  v_pk_fma_f32 v[42:43], v[66:67], v[30:31], v[42:43] op_sel_hi:[1,0,1]
  v_pk_fma_f32 v[44:45], v[68:69], v[30:31], v[44:45] op_sel_hi:[1,0,1]
  v_pk_fma_f32 v[46:47], v[70:71], v[30:31], v[46:47] op_sel_hi:[1,0,1]
  v_cvt_pk_bf16_f32 v40, v40, v41
  v_cvt_pk_bf16_f32 v41, v42, v43
  v_cvt_pk_bf16_f32 v42, v44, v45
  v_cvt_pk_bf16_f32 v43, v46, v47
  global_store_dwordx4 v126, v[40:43], s[26:27] sc1
  v_mul_f32 v34, v24, v25
  v_fmac_f32 v34, v26, v27
  v_fmac_f32 v34, v28, v29
  v_fmac_f32 v34, v30, v31
  s_mov_b32 exec_lo, 0x00010001
  s_mov_b32 exec_hi, 0x00010001
  global_store_dwordx4 v127, v[32:35], s[26:27] sc1
  v_mov_b32 v117, 2
  ds_write_b32 v1, v117 offset:4
L_sdone:
  s_endpgm
L_newmax:
  v_permlane16_swap_b32 v110, v111
  v_max_f32 v116, v110, v111
  v_max_f32 v117, v110, v111
  s_nop 1
  v_permlane32_swap_b32 v116, v117
  v_max_f32 v18, v116, v117
  v_mul_f32 v117, 0xbfb8aa3b, v18
  v_floor_f32 v117, v117
  v_cmp_lt_f32 vcc, v117, v19
  v_sub_f32 v118, v117, v19
  v_fma_f32 v112, v112, s45, v117
  v_fma_f32 v113, v113, s45, v117
  v_fma_f32 v114, v114, s45, v117
  v_fma_f32 v115, v115, s45, v117
  v_exp_f32 v118, v118
  v_exp_f32 v112, v112
  v_exp_f32 v113, v113
  v_exp_f32 v114, v114
  v_exp_f32 v115, v115
  v_mov_b32 v19, v117
  s_cbranch_vccz L_nors
  v_pk_mul_f32 v[76:77], v[76:77], v[118:119] op_sel_hi:[1,0]
  v_pk_mul_f32 v[78:79], v[78:79], v[118:119] op_sel_hi:[1,0]
  v_pk_mul_f32 v[80:81], v[80:81], v[118:119] op_sel_hi:[1,0]
  v_pk_mul_f32 v[82:83], v[82:83], v[118:119] op_sel_hi:[1,0]
  v_pk_mul_f32 v[84:85], v[84:85], v[118:119] op_sel_hi:[1,0]
  v_pk_mul_f32 v[86:87], v[86:87], v[118:119] op_sel_hi:[1,0]
  v_pk_mul_f32 v[88:89], v[88:89], v[118:119] op_sel_hi:[1,0]
  v_pk_mul_f32 v[90:91], v[90:91], v[118:119] op_sel_hi:[1,0]
  v_pk_mul_f32 v[92:93], v[92:93], v[118:119] op_sel_hi:[1,0]
  v_pk_mul_f32 v[94:95], v[94:95], v[118:119] op_sel_hi:[1,0]
  v_pk_mul_f32 v[96:97], v[96:97], v[118:119] op_sel_hi:[1,0]
  v_pk_mul_f32 v[98:99], v[98:99], v[118:119] op_sel_hi:[1,0]
  v_pk_mul_f32 v[100:101], v[100:101], v[118:119] op_sel_hi:[1,0]
  v_pk_mul_f32 v[102:103], v[102:103], v[118:119] op_sel_hi:[1,0]
  v_pk_mul_f32 v[104:105], v[104:105], v[118:119] op_sel_hi:[1,0]
  v_pk_mul_f32 v[106:107], v[106:107], v[118:119] op_sel_hi:[1,0]
  s_branch L_nors
L_kk:
  ds_read_b128 v[40:43], v6 offset:0
  ds_read_b128 v[44:47], v7 offset:0
  ds_read_b128 v[48:51], v8 offset:0
  ds_read_b128 v[52:55], v9 offset:0
  ds_read_b128 v[56:59], v6 offset:4096
  ds_read_b128 v[60:63], v7 offset:4096
  ds_read_b128 v[64:67], v8 offset:4096
  ds_read_b128 v[68:71], v9 offset:4096
  s_lshl_b32 s48, s63, 8
  v_add_u32 v116, s48, v23
  s_waitcnt lgkmcnt(7)
  v_mfma_f32_16x16x32_bf16 v[72:75], v[40:43], v[24:27], 0
  s_waitcnt lgkmcnt(6)
  v_mfma_f32_16x16x32_bf16 v[72:75], v[44:47], v[28:31], v[72:75]
  s_waitcnt lgkmcnt(5)
  v_mfma_f32_16x16x32_bf16 v[72:75], v[48:51], v[32:35], v[72:75]
  s_waitcnt lgkmcnt(4)
  v_mfma_f32_16x16x32_bf16 v[72:75], v[52:55], v[36:39], v[72:75]
  s_waitcnt lgkmcnt(3)
  v_mfma_f32_16x16x32_bf16 v[112:115], v[56:59], v[24:27], 0
  s_waitcnt lgkmcnt(2)
  v_mfma_f32_16x16x32_bf16 v[112:115], v[60:63], v[28:31], v[112:115]
  s_waitcnt lgkmcnt(1)
  v_mfma_f32_16x16x32_bf16 v[112:115], v[64:67], v[32:35], v[112:115]
  s_waitcnt lgkmcnt(0)
  v_mfma_f32_16x16x32_bf16 v[112:115], v[68:71], v[36:39], v[112:115]
  v_xor_b32 v6, s54, v6
  v_xor_b32 v7, s54, v7
  v_xor_b32 v8, s54, v8
  v_xor_b32 v9, s54, v9
  v_xor_b32 v10, s54, v10
  v_xor_b32 v11, s54, v11
  v_xor_b32 v12, s54, v12
  v_xor_b32 v13, s54, v13
  v_xor_b32 v14, s54, v14
  v_xor_b32 v15, s54, v15
  v_xor_b32 v16, s54, v16
  v_xor_b32 v17, s54, v17
  v_cvt_pk_bf16_f32 v40, v72, v73
  v_cvt_pk_bf16_f32 v41, v74, v75
  v_cvt_pk_bf16_f32 v42, v112, v113
  v_cvt_pk_bf16_f32 v43, v114, v115
  v_lshlrev_b32 v44, 16, v40
  v_and_b32 v45, 0xffff0000, v40
  v_lshlrev_b32 v46, 16, v41
  v_and_b32 v47, 0xffff0000, v41
  v_lshlrev_b32 v48, 16, v42
  v_and_b32 v49, 0xffff0000, v42
  v_lshlrev_b32 v50, 16, v43
  v_and_b32 v51, 0xffff0000, v43
  v_mul_f32 v44, 0x3db504f3, v44
  v_mul_f32 v45, 0x3db504f3, v45
  v_mul_f32 v46, 0x3db504f3, v46
  v_mul_f32 v47, 0x3db504f3, v47
  v_mul_f32 v48, 0x3db504f3, v48
  v_mul_f32 v49, 0x3db504f3, v49
  v_mul_f32 v50, 0x3db504f3, v50
  v_mul_f32 v51, 0x3db504f3, v51
  v_cvt_pk_bf16_f32 v40, v44, v45
  v_cvt_pk_bf16_f32 v41, v46, v47
  v_cvt_pk_bf16_f32 v42, v48, v49
  v_cvt_pk_bf16_f32 v43, v50, v51
  ds_write_b64 v116, v[40:41]
  ds_write_b64 v116, v[42:43] offset:128
  s_branch L_skipc
L_vv:
  s_lshl_b32 s48, s48, 8
  v_add_u32 v116, s48, v23
  ds_read_b64 v[72:73], v116
  ds_read_b64 v[74:75], v116 offset:128
  ds_read_b64_tr_b16 v[40:41], v10
  ds_read_b64_tr_b16 v[42:43], v10 offset:4096
  ds_read_b64_tr_b16 v[44:45], v11
  ds_read_b64_tr_b16 v[46:47], v11 offset:4096
  ds_read_b64_tr_b16 v[48:49], v12
  ds_read_b64_tr_b16 v[50:51], v12 offset:4096
  ds_read_b64_tr_b16 v[52:53], v13
  ds_read_b64_tr_b16 v[54:55], v13 offset:4096
  ds_read_b64_tr_b16 v[56:57], v14
  ds_read_b64_tr_b16 v[58:59], v14 offset:4096
  ds_read_b64_tr_b16 v[60:61], v15
  ds_read_b64_tr_b16 v[62:63], v15 offset:4096
  ds_read_b64_tr_b16 v[64:65], v16
  ds_read_b64_tr_b16 v[66:67], v16 offset:4096
  ds_read_b64_tr_b16 v[68:69], v17
  ds_read_b64_tr_b16 v[70:71], v17 offset:4096
  s_waitcnt lgkmcnt(15)
  v_lshlrev_b32 v128, 16, v72
  v_and_b32 v129, 0xffff0000, v72
  v_lshlrev_b32 v130, 16, v73
  v_and_b32 v131, 0xffff0000, v73
  v_lshlrev_b32 v132, 16, v74
  v_and_b32 v133, 0xffff0000, v74
  v_lshlrev_b32 v134, 16, v75
  v_and_b32 v135, 0xffff0000, v75
  v_max3_f32 v116, v128, v129, v130
  v_max3_f32 v117, v131, v132, v133
  v_max3_f32 v112, v134, v135, v18
  v_fma_f32 v136, v128, s45, v19
  v_fma_f32 v137, v129, s45, v19
  v_fma_f32 v138, v130, s45, v19
  v_fma_f32 v139, v131, s45, v19
  v_fma_f32 v140, v132, s45, v19
  v_fma_f32 v141, v133, s45, v19
  v_fma_f32 v142, v134, s45, v19
  v_fma_f32 v143, v135, s45, v19
  v_max3_f32 v110, v116, v117, v112
  v_max3_f32 v111, v116, v117, v112
  v_cmp_gt_f32 vcc, v110, v18
  v_mov_b32 v118, 1.0
  s_cbranch_vccz L_vv2
  v_permlane16_swap_b32 v110, v111
  v_max_f32 v116, v110, v111
  v_max_f32 v117, v110, v111
  s_nop 1
  v_permlane32_swap_b32 v116, v117
  v_max_f32 v18, v116, v117
  v_mul_f32 v117, 0xbfb8aa3b, v18
  v_floor_f32 v117, v117
  v_sub_f32 v118, v117, v19
  v_fma_f32 v136, v128, s45, v117
  v_fma_f32 v137, v129, s45, v117
  v_fma_f32 v138, v130, s45, v117
  v_fma_f32 v139, v131, s45, v117
  v_fma_f32 v140, v132, s45, v117
  v_fma_f32 v141, v133, s45, v117
  v_fma_f32 v142, v134, s45, v117
  v_fma_f32 v143, v135, s45, v117
  v_exp_f32 v118, v118
  v_mov_b32 v19, v117
  v_pk_mul_f32 v[76:77], v[76:77], v[118:119] op_sel_hi:[1,0]
  v_pk_mul_f32 v[78:79], v[78:79], v[118:119] op_sel_hi:[1,0]
  v_pk_mul_f32 v[80:81], v[80:81], v[118:119] op_sel_hi:[1,0]
  v_pk_mul_f32 v[82:83], v[82:83], v[118:119] op_sel_hi:[1,0]
  v_pk_mul_f32 v[84:85], v[84:85], v[118:119] op_sel_hi:[1,0]
  v_pk_mul_f32 v[86:87], v[86:87], v[118:119] op_sel_hi:[1,0]
  v_pk_mul_f32 v[88:89], v[88:89], v[118:119] op_sel_hi:[1,0]
  v_pk_mul_f32 v[90:91], v[90:91], v[118:119] op_sel_hi:[1,0]
  v_pk_mul_f32 v[92:93], v[92:93], v[118:119] op_sel_hi:[1,0]
  v_pk_mul_f32 v[94:95], v[94:95], v[118:119] op_sel_hi:[1,0]
  v_pk_mul_f32 v[96:97], v[96:97], v[118:119] op_sel_hi:[1,0]
  v_pk_mul_f32 v[98:99], v[98:99], v[118:119] op_sel_hi:[1,0]
  v_pk_mul_f32 v[100:101], v[100:101], v[118:119] op_sel_hi:[1,0]
  v_pk_mul_f32 v[102:103], v[102:103], v[118:119] op_sel_hi:[1,0]
  v_pk_mul_f32 v[104:105], v[104:105], v[118:119] op_sel_hi:[1,0]
  v_pk_mul_f32 v[106:107], v[106:107], v[118:119] op_sel_hi:[1,0]
L_vv2:
  v_exp_f32 v136, v136
  v_exp_f32 v137, v137
  v_exp_f32 v138, v138
  v_exp_f32 v139, v139
  v_exp_f32 v140, v140
  v_exp_f32 v141, v141
  v_exp_f32 v142, v142
  v_exp_f32 v143, v143
  v_xor_b32 v6, s54, v6
  v_xor_b32 v7, s54, v7
  v_xor_b32 v8, s54, v8
  v_xor_b32 v9, s54, v9
  v_xor_b32 v10, s54, v10
  v_xor_b32 v11, s54, v11
  v_xor_b32 v12, s54, v12
  v_xor_b32 v13, s54, v13
  v_xor_b32 v14, s54, v14
  v_xor_b32 v15, s54, v15
  v_xor_b32 v16, s54, v16
  v_xor_b32 v17, s54, v17
  v_cvt_pk_bf16_f32 v72, v136, v137
  v_cvt_pk_bf16_f32 v73, v138, v139
  v_cvt_pk_bf16_f32 v74, v140, v141
  v_cvt_pk_bf16_f32 v75, v142, v143
  v_pk_add_f32 v[136:137], v[136:137], v[140:141]
  v_pk_add_f32 v[138:139], v[138:139], v[142:143]
  v_pk_add_f32 v[136:137], v[136:137], v[138:139]
  v_add_f32 v136, v136, v137
  v_fma_f32 v109, v109, v118, v136
  s_waitcnt lgkmcnt(0)
  v_mfma_f32_16x16x32_bf16 v[76:79], v[40:43], v[72:75], v[76:79]
  v_mfma_f32_16x16x32_bf16 v[80:83], v[44:47], v[72:75], v[80:83]
  v_mfma_f32_16x16x32_bf16 v[84:87], v[48:51], v[72:75], v[84:87]
  v_mfma_f32_16x16x32_bf16 v[88:91], v[52:55], v[72:75], v[88:91]
  v_mfma_f32_16x16x32_bf16 v[92:95], v[56:59], v[72:75], v[92:95]
  v_mfma_f32_16x16x32_bf16 v[96:99], v[60:63], v[72:75], v[96:99]
  v_mfma_f32_16x16x32_bf16 v[100:103], v[64:67], v[72:75], v[100:103]
  v_mfma_f32_16x16x32_bf16 v[104:107], v[68:71], v[72:75], v[104:107]
  s_branch L_skipc
L_helper:
  s_mov_b32 s47, s39
  s_mov_b32 s50, s39
  s_cmp_eq_u32 s37, 15
  s_cselect_b32 s47, 3, s47
  s_sub_u32 s39, s3, 4
  s_and_b32 s48, s37, 7
  s_mul_i32 s59, s36, 7
  s_add_u32 s59, s59, s48
  s_lshl_b32 s49, s48, 3
  s_add_u32 s49, s49, s36
  v_lshrrev_b32 v20, 4, v0
  v_and_b32 v21, 15, v0
  v_lshrrev_b32 v22, 3, v21
  v_and_b32 v23, 7, v21
  s_mov_b32 s44, 0x05040100
  s_mov_b32 s45, 0x07060302
  s_cmp_eq_u32 s39, 0
  s_cbranch_scc1 L_w4
  s_cmp_ge_u32 s47, 2
  s_cbranch_scc1 L_end
  v_mov_b32 v1, 160904
L_hq:
  s_sleep 4
  ds_read_b32 v2, v1
  s_waitcnt lgkmcnt(0)
  v_readfirstlane_b32 s40, v2
  s_cmp_eq_u32 s40, 0
  s_cbranch_scc1 L_hq
  ds_read_b32 v3, v1 offset:8
  s_waitcnt vmcnt(0) lgkmcnt(0)
  s_branch L_roles
L_w4:
  s_setprio 3
  v_mov_b32 v72, -1
  v_mov_b32 v73, -1
  v_mov_b32 v74, -1
  v_mov_b32 v75, -1
  s_lshl_b32 s40, s36, 15
  s_lshl_b32 s41, s38, 8
  s_add_u32 s40, s40, s41
  s_add_u32 s40, s40, 65536
  v_lshlrev_b32 v76, 13, v20
  v_lshl_add_u32 v76, v21, 4, v76
  v_add_u32 v76, s40, v76
  s_lshl_b32 s40, s36, 12
  s_lshl_b32 s41, s38, 7
  s_add_u32 s41, s40, s41
  s_add_u32 s41, s41, 983040
  v_lshl_add_u32 v77, v20, 3, s41
  v_add_u32 v10, 157696, v1
  s_lshl_b32 s40, s50, 8
  s_add_u32 s40, s40, 157696
  v_lshl_add_u32 v11, v20, 4, s40
  v_bfe_u32 v13, v0, 2, 2
  v_lshl_add_u32 v13, v20, 3, v13
  v_lshlrev_b32 v13, 7, v13
  v_and_b32 v14, 3, v0
  v_lshl_add_u32 v13, v14, 3, v13
  v_add_u32 v13, 131072, v13
  v_lshlrev_b32 v14, 2, v0
  v_add_u32 v18, 159744, v14
  s_lshl_b32 s40, s36, 14
  s_add_u32 s40, s40, 856064
  v_add_u32 v17, s40, v1
  v_add_u32 v19, 0x2000, v17
  s_lshl_b32 s41, s50, 12
  s_add_u32 s40, s40, s41
  s_lshl_b32 s41, s48, 9
  s_add_u32 s40, s40, s41
  s_sub_u32 s40, s40, 4096
  v_lshl_add_u32 v15, v0, 3, s40
  s_lshl_b32 s40, s2, 2
  s_add_u32 s40, s40, 1024
  v_mov_b32 v78, s40
  v_cmp_eq_u32 s[52:53], 1, v20
  v_cmp_eq_u32 s[54:55], 2, v20
  v_cmp_eq_u32 s[56:57], 3, v20
  v_mov_b32 v14, 160908
  s_waitcnt vmcnt(0)
  global_store_dwordx4 v76, v[72:75], s[26:27] sc1
  s_cmp_ge_u32 s47, 2
  s_cbranch_scc0 L_w4r
L_w4b:
  v_add_u32 v3, 0x9e3779b9, v3
  v_lshlrev_b32 v24, 16, v4
  v_and_b32 v25, 0xffff0000, v4
  v_lshlrev_b32 v26, 16, v5
  v_and_b32 v27, 0xffff0000, v5
  v_lshlrev_b32 v28, 16, v6
  v_and_b32 v29, 0xffff0000, v6
  v_lshlrev_b32 v30, 16, v7
  v_and_b32 v31, 0xffff0000, v7
  v_add_f32 v32, v24, v25
  v_add_f32 v33, v26, v27
  v_add_f32 v34, v28, v29
  v_add_f32 v35, v30, v31
  v_add_f32 v32, v32, v33
  v_add_f32 v34, v34, v35
  v_add_f32 v32, v32, v34
  s_nop 1
  v_add_f32_dpp v32, v32, v32 row_ror:8 row_mask:0xf bank_mask:0xf
  s_nop 1
  v_add_f32_dpp v32, v32, v32 row_ror:4 row_mask:0xf bank_mask:0xf
  s_nop 1
  v_add_f32_dpp v32, v32, v32 row_ror:2 row_mask:0xf bank_mask:0xf
  s_nop 1
  v_add_f32_dpp v32, v32, v32 row_ror:1 row_mask:0xf bank_mask:0xf
  v_mov_b32 v33, v32
  s_nop 1
  v_permlane16_swap_b32 v32, v33
  v_add_f32 v32, v32, v33
  v_mov_b32 v33, v32
  s_nop 1
  v_permlane32_swap_b32 v32, v33
  v_add_f32 v32, v32, v33
  v_mul_f32 v32, 0x3b000000, v32
  v_sub_f32 v34, v24, v32
  v_mul_f32 v33, v34, v34
  v_sub_f32 v34, v25, v32
  v_fmac_f32 v33, v34, v34
  v_sub_f32 v34, v26, v32
  v_fmac_f32 v33, v34, v34
  v_sub_f32 v34, v27, v32
  v_fmac_f32 v33, v34, v34
  v_sub_f32 v34, v28, v32
  v_fmac_f32 v33, v34, v34
  v_sub_f32 v34, v29, v32
  v_fmac_f32 v33, v34, v34
  v_sub_f32 v34, v30, v32
  v_fmac_f32 v33, v34, v34
  v_sub_f32 v34, v31, v32
  v_fmac_f32 v33, v34, v34
  v_cvt_pk_bf16_f32 v32, v32, v32
  v_and_b32 v32, 0xffff0000, v32
  s_nop 1
  v_add_f32_dpp v33, v33, v33 row_ror:8 row_mask:0xf bank_mask:0xf
  s_nop 1
  v_add_f32_dpp v33, v33, v33 row_ror:4 row_mask:0xf bank_mask:0xf
  s_nop 1
  v_add_f32_dpp v33, v33, v33 row_ror:2 row_mask:0xf bank_mask:0xf
  s_nop 1
  v_add_f32_dpp v33, v33, v33 row_ror:1 row_mask:0xf bank_mask:0xf
  v_mov_b32 v34, v33
  s_nop 1
  v_permlane16_swap_b32 v33, v34
  v_add_f32 v33, v33, v34
  v_mov_b32 v34, v33
  s_nop 1
  v_permlane32_swap_b32 v33, v34
  v_add_f32 v33, v33, v34
  v_mul_f32 v33, 0x3b000000, v33
  v_cvt_pk_bf16_f32 v33, v33, v33
  v_and_b32 v33, 0xffff0000, v33
  v_add_f32 v33, 0x3727c5ac, v33
  v_cvt_pk_bf16_f32 v33, v33, v33
  v_and_b32 v33, 0xffff0000, v33
  v_sqrt_f32 v33, v33
  v_sub_f32 v24, v24, v32
  v_sub_f32 v25, v25, v32
  v_sub_f32 v26, v26, v32
  v_sub_f32 v27, v27, v32
  v_sub_f32 v28, v28, v32
  v_sub_f32 v29, v29, v32
  v_sub_f32 v30, v30, v32
  v_sub_f32 v31, v31, v32
  v_cvt_pk_bf16_f32 v33, v33, v33
  v_and_b32 v33, 0xffff0000, v33
  v_rcp_f32 v33, v33
  v_cvt_pk_bf16_f32 v4, v24, v25
  v_cvt_pk_bf16_f32 v5, v26, v27
  v_cvt_pk_bf16_f32 v6, v28, v29
  v_cvt_pk_bf16_f32 v7, v30, v31
  v_lshlrev_b32 v24, 16, v4
  v_and_b32 v25, 0xffff0000, v4
  v_lshlrev_b32 v26, 16, v5
  v_and_b32 v27, 0xffff0000, v5
  v_lshlrev_b32 v28, 16, v6
  v_and_b32 v29, 0xffff0000, v6
  v_lshlrev_b32 v30, 16, v7
  v_and_b32 v31, 0xffff0000, v7
  v_mul_f32 v24, v24, v33
  v_mul_f32 v25, v25, v33
  v_mul_f32 v26, v26, v33
  v_mul_f32 v27, v27, v33
  v_mul_f32 v28, v28, v33
  v_mul_f32 v29, v29, v33
  v_mul_f32 v30, v30, v33
  v_mul_f32 v31, v31, v33
  v_cvt_pk_bf16_f32 v4, v24, v25
  v_cvt_pk_bf16_f32 v5, v26, v27
  v_cvt_pk_bf16_f32 v6, v28, v29
  v_cvt_pk_bf16_f32 v7, v30, v31
  ds_write_b128 v10, v[4:7]
  ds_read_b128 v[40:43], v11 offset:0
  ds_read_b128 v[44:47], v11 offset:64
  ds_read_b128 v[48:51], v11 offset:128
  ds_read_b128 v[52:55], v11 offset:192
L_wqw:
  ds_read_b32 v24, v14
  s_waitcnt lgkmcnt(0)
  v_readfirstlane_b32 s40, v24
  s_cmp_lt_u32 s40, 4
  s_cbranch_scc1 L_wqw
  ds_read_b64_tr_b16 v[96:97], v13 offset:0
  ds_read_b64_tr_b16 v[98:99], v13 offset:512
  ds_read_b64_tr_b16 v[100:101], v13 offset:32
  ds_read_b64_tr_b16 v[102:103], v13 offset:544
  ds_read_b64_tr_b16 v[104:105], v13 offset:64
  ds_read_b64_tr_b16 v[106:107], v13 offset:576
  ds_read_b64_tr_b16 v[108:109], v13 offset:96
  ds_read_b64_tr_b16 v[110:111], v13 offset:608
  ds_read_b64_tr_b16 v[112:113], v13 offset:4096
  ds_read_b64_tr_b16 v[114:115], v13 offset:4608
  ds_read_b64_tr_b16 v[116:117], v13 offset:4128
  ds_read_b64_tr_b16 v[118:119], v13 offset:4640
  ds_read_b64_tr_b16 v[120:121], v13 offset:4160
  ds_read_b64_tr_b16 v[122:123], v13 offset:4672
  ds_read_b64_tr_b16 v[124:125], v13 offset:4192
  ds_read_b64_tr_b16 v[126:127], v13 offset:4704
  ds_read_b64_tr_b16 v[128:129], v13 offset:8192
  ds_read_b64_tr_b16 v[130:131], v13 offset:8704
  ds_read_b64_tr_b16 v[132:133], v13 offset:8224
  ds_read_b64_tr_b16 v[134:135], v13 offset:8736
  ds_read_b64_tr_b16 v[136:137], v13 offset:8256
  ds_read_b64_tr_b16 v[138:139], v13 offset:8768
  ds_read_b64_tr_b16 v[140:141], v13 offset:8288
  ds_read_b64_tr_b16 v[142:143], v13 offset:8800
  ds_read_b64_tr_b16 v[144:145], v13 offset:12288
  ds_read_b64_tr_b16 v[146:147], v13 offset:12800
  ds_read_b64_tr_b16 v[148:149], v13 offset:12320
  ds_read_b64_tr_b16 v[150:151], v13 offset:12832
  ds_read_b64_tr_b16 v[152:153], v13 offset:12352
  ds_read_b64_tr_b16 v[154:155], v13 offset:12864
  ds_read_b64_tr_b16 v[156:157], v13 offset:12384
  ds_read_b64_tr_b16 v[158:159], v13 offset:12896
  s_waitcnt lgkmcnt(15)
  v_mfma_f32_16x16x32_bf16 v[56:59], v[40:43], v[96:99], 0
  s_waitcnt lgkmcnt(15)
  v_mfma_f32_16x16x32_bf16 v[60:63], v[40:43], v[100:103], 0
  s_waitcnt lgkmcnt(15)
  v_mfma_f32_16x16x32_bf16 v[64:67], v[40:43], v[104:107], 0
  s_waitcnt lgkmcnt(15)
  v_mfma_f32_16x16x32_bf16 v[68:71], v[40:43], v[108:111], 0
  s_waitcnt lgkmcnt(15)
  v_mfma_f32_16x16x32_bf16 v[56:59], v[44:47], v[112:115], v[56:59]
  s_waitcnt lgkmcnt(15)
  v_mfma_f32_16x16x32_bf16 v[60:63], v[44:47], v[116:119], v[60:63]
  s_waitcnt lgkmcnt(15)
  v_mfma_f32_16x16x32_bf16 v[64:67], v[44:47], v[120:123], v[64:67]
  s_waitcnt lgkmcnt(15)
  v_mfma_f32_16x16x32_bf16 v[68:71], v[44:47], v[124:127], v[68:71]
  s_waitcnt lgkmcnt(14)
  v_mfma_f32_16x16x32_bf16 v[56:59], v[48:51], v[128:131], v[56:59]
  s_waitcnt lgkmcnt(12)
  v_mfma_f32_16x16x32_bf16 v[60:63], v[48:51], v[132:135], v[60:63]
  s_waitcnt lgkmcnt(10)
  v_mfma_f32_16x16x32_bf16 v[64:67], v[48:51], v[136:139], v[64:67]
  s_waitcnt lgkmcnt(8)
  v_mfma_f32_16x16x32_bf16 v[68:71], v[48:51], v[140:143], v[68:71]
  s_waitcnt lgkmcnt(6)
  v_mfma_f32_16x16x32_bf16 v[56:59], v[52:55], v[144:147], v[56:59]
  s_waitcnt lgkmcnt(4)
  v_mfma_f32_16x16x32_bf16 v[60:63], v[52:55], v[148:151], v[60:63]
  s_waitcnt lgkmcnt(2)
  v_mfma_f32_16x16x32_bf16 v[64:67], v[52:55], v[152:155], v[64:67]
  s_waitcnt lgkmcnt(0)
  v_mfma_f32_16x16x32_bf16 v[68:71], v[52:55], v[156:159], v[68:71]
  s_nop 5
  v_cndmask_b32 v2, v56, v60, s[52:53]
  s_nop 0
  v_cndmask_b32 v2, v2, v64, s[54:55]
  v_cndmask_b32 v2, v2, v68, s[56:57]
  s_waitcnt vmcnt(0)
  global_store_dwordx2 v15, v[2:3], s[26:27] sc1
  s_mov_b32 s51, 262144
  s_waitcnt vmcnt(0)
L_qgo:
  s_mov_b32 s55, 65535
L_qpoll:
  s_bitcmp1_b32 s55, 0
  s_cbranch_scc0 L_qs0
  global_load_dwordx4 v[96:99], v17, s[26:27] offset:-4096 sc1
L_qs0:
  s_bitcmp1_b32 s55, 1
  s_cbranch_scc0 L_qs1
  global_load_dwordx4 v[100:103], v17, s[26:27] offset:-3072 sc1
L_qs1:
  s_bitcmp1_b32 s55, 2
  s_cbranch_scc0 L_qs2
  global_load_dwordx4 v[104:107], v17, s[26:27] offset:-2048 sc1
L_qs2:
  s_bitcmp1_b32 s55, 3
  s_cbranch_scc0 L_qs3
  global_load_dwordx4 v[108:111], v17, s[26:27] offset:-1024 sc1
L_qs3:
  s_bitcmp1_b32 s55, 4
  s_cbranch_scc0 L_qs4
  global_load_dwordx4 v[112:115], v17, s[26:27] offset:0 sc1
L_qs4:
  s_bitcmp1_b32 s55, 5
  s_cbranch_scc0 L_qs5
  global_load_dwordx4 v[116:119], v17, s[26:27] offset:1024 sc1
L_qs5:
  s_bitcmp1_b32 s55, 6
  s_cbranch_scc0 L_qs6
  global_load_dwordx4 v[120:123], v17, s[26:27] offset:2048 sc1
L_qs6:
  s_bitcmp1_b32 s55, 7
  s_cbranch_scc0 L_qs7
  global_load_dwordx4 v[124:127], v17, s[26:27] offset:3072 sc1
L_qs7:
  s_bitcmp1_b32 s55, 8
  s_cbranch_scc0 L_qs8
  global_load_dwordx4 v[128:131], v19, s[26:27] offset:-4096 sc1
L_qs8:
  s_bitcmp1_b32 s55, 9
  s_cbranch_scc0 L_qs9
  global_load_dwordx4 v[132:135], v19, s[26:27] offset:-3072 sc1
L_qs9:
  s_bitcmp1_b32 s55, 10
  s_cbranch_scc0 L_qs10
  global_load_dwordx4 v[136:139], v19, s[26:27] offset:-2048 sc1
L_qs10:
  s_bitcmp1_b32 s55, 11
  s_cbranch_scc0 L_qs11
  global_load_dwordx4 v[140:143], v19, s[26:27] offset:-1024 sc1
L_qs11:
  s_bitcmp1_b32 s55, 12
  s_cbranch_scc0 L_qs12
  global_load_dwordx4 v[144:147], v19, s[26:27] offset:0 sc1
L_qs12:
  s_bitcmp1_b32 s55, 13
  s_cbranch_scc0 L_qs13
  global_load_dwordx4 v[148:151], v19, s[26:27] offset:1024 sc1
L_qs13:
  s_bitcmp1_b32 s55, 14
  s_cbranch_scc0 L_qs14
  global_load_dwordx4 v[152:155], v19, s[26:27] offset:2048 sc1
L_qs14:
  s_bitcmp1_b32 s55, 15
  s_cbranch_scc0 L_qs15
  global_load_dwordx4 v[156:159], v19, s[26:27] offset:3072 sc1
L_qs15:
  s_waitcnt vmcnt(0)
  v_cmp_ne_u32 vcc, v97, v3
  v_cmp_ne_u32 s[40:41], v99, v3
  s_or_b64 vcc, vcc, s[40:41]
  s_cbranch_scc1 L_qc0
  s_bitset0_b32 s55, 0
L_qc0:
  v_cmp_ne_u32 vcc, v101, v3
  v_cmp_ne_u32 s[40:41], v103, v3
  s_or_b64 vcc, vcc, s[40:41]
  s_cbranch_scc1 L_qc1
  s_bitset0_b32 s55, 1
L_qc1:
  v_cmp_ne_u32 vcc, v105, v3
  v_cmp_ne_u32 s[40:41], v107, v3
  s_or_b64 vcc, vcc, s[40:41]
  s_cbranch_scc1 L_qc2
  s_bitset0_b32 s55, 2
L_qc2:
  v_cmp_ne_u32 vcc, v109, v3
  v_cmp_ne_u32 s[40:41], v111, v3
  s_or_b64 vcc, vcc, s[40:41]
  s_cbranch_scc1 L_qc3
  s_bitset0_b32 s55, 3
L_qc3:
  v_cmp_ne_u32 vcc, v113, v3
  v_cmp_ne_u32 s[40:41], v115, v3
  s_or_b64 vcc, vcc, s[40:41]
  s_cbranch_scc1 L_qc4
  s_bitset0_b32 s55, 4
L_qc4:
  v_cmp_ne_u32 vcc, v117, v3
  v_cmp_ne_u32 s[40:41], v119, v3
  s_or_b64 vcc, vcc, s[40:41]
  s_cbranch_scc1 L_qc5
  s_bitset0_b32 s55, 5
L_qc5:
  v_cmp_ne_u32 vcc, v121, v3
  v_cmp_ne_u32 s[40:41], v123, v3
  s_or_b64 vcc, vcc, s[40:41]
  s_cbranch_scc1 L_qc6
  s_bitset0_b32 s55, 6
L_qc6:
  v_cmp_ne_u32 vcc, v125, v3
  v_cmp_ne_u32 s[40:41], v127, v3
  s_or_b64 vcc, vcc, s[40:41]
  s_cbranch_scc1 L_qc7
  s_bitset0_b32 s55, 7
L_qc7:
  v_cmp_ne_u32 vcc, v129, v3
  v_cmp_ne_u32 s[40:41], v131, v3
  s_or_b64 vcc, vcc, s[40:41]
  s_cbranch_scc1 L_qc8
  s_bitset0_b32 s55, 8
L_qc8:
  v_cmp_ne_u32 vcc, v133, v3
  v_cmp_ne_u32 s[40:41], v135, v3
  s_or_b64 vcc, vcc, s[40:41]
  s_cbranch_scc1 L_qc9
  s_bitset0_b32 s55, 9
L_qc9:
  v_cmp_ne_u32 vcc, v137, v3
  v_cmp_ne_u32 s[40:41], v139, v3
  s_or_b64 vcc, vcc, s[40:41]
  s_cbranch_scc1 L_qc10
  s_bitset0_b32 s55, 10
L_qc10:
  v_cmp_ne_u32 vcc, v141, v3
  v_cmp_ne_u32 s[40:41], v143, v3
  s_or_b64 vcc, vcc, s[40:41]
  s_cbranch_scc1 L_qc11
  s_bitset0_b32 s55, 11
L_qc11:
  v_cmp_ne_u32 vcc, v145, v3
  v_cmp_ne_u32 s[40:41], v147, v3
  s_or_b64 vcc, vcc, s[40:41]
  s_cbranch_scc1 L_qc12
  s_bitset0_b32 s55, 12
L_qc12:
  v_cmp_ne_u32 vcc, v149, v3
  v_cmp_ne_u32 s[40:41], v151, v3
  s_or_b64 vcc, vcc, s[40:41]
  s_cbranch_scc1 L_qc13
  s_bitset0_b32 s55, 13
L_qc13:
  v_cmp_ne_u32 vcc, v153, v3
  v_cmp_ne_u32 s[40:41], v155, v3
  s_or_b64 vcc, vcc, s[40:41]
  s_cbranch_scc1 L_qc14
  s_bitset0_b32 s55, 14
L_qc14:
  v_cmp_ne_u32 vcc, v157, v3
  v_cmp_ne_u32 s[40:41], v159, v3
  s_or_b64 vcc, vcc, s[40:41]
  s_cbranch_scc1 L_qc15
  s_bitset0_b32 s55, 15
L_qc15:
  s_sub_u32 s51, s51, 1
  s_cbranch_scc1 L_qgot
  s_cmp_lg_u32 s55, 0
  s_cbranch_scc1 L_qpoll
L_qgot:
  v_add_f32 v96, v96, v112
  v_add_f32 v128, v128, v144
  v_add_f32 v98, v98, v114
  v_add_f32 v130, v130, v146
  v_add_f32 v100, v100, v116
  v_add_f32 v132, v132, v148
  v_add_f32 v102, v102, v118
  v_add_f32 v134, v134, v150
  v_add_f32 v104, v104, v120
  v_add_f32 v136, v136, v152
  v_add_f32 v106, v106, v122
  v_add_f32 v138, v138, v154
  v_add_f32 v108, v108, v124
  v_add_f32 v140, v140, v156
  v_add_f32 v110, v110, v126
  v_add_f32 v142, v142, v158
  v_add_f32 v96, v96, v128
  v_add_f32 v98, v98, v130
  v_add_f32 v100, v100, v132
  v_add_f32 v102, v102, v134
  v_add_f32 v104, v104, v136
  v_add_f32 v106, v106, v138
  v_add_f32 v108, v108, v140
  v_add_f32 v110, v110, v142
  v_cvt_pk_bf16_f32 v24, v96, v98
  v_cvt_pk_bf16_f32 v25, v100, v102
  v_cvt_pk_bf16_f32 v26, v104, v106
  v_cvt_pk_bf16_f32 v27, v108, v110
  ds_write2_b32 v18, v24, v25 offset0:0 offset1:64
  ds_write2_b32 v18, v26, v27 offset0:128 offset1:192
  v_mov_b32 v18, 160904
  v_mov_b32 v19, 1
  ds_write_b32 v18, v3 offset:8
  ds_write_b32 v18, v19
  s_waitcnt lgkmcnt(0)
  s_setprio 0
  s_cmp_lg_u32 s37, 16
  s_cbranch_scc1 L_nogok
  s_lshl_b32 s40, s36, 2
  s_add_u32 s40, s40, 1024
  v_mov_b32 v78, s40
  s_mov_b64 exec, 1
  global_store_dword v78, v3, s[26:27] sc1
  s_mov_b64 exec, -1
L_nogok:
  s_waitcnt vmcnt(0)
  s_branch L_roles
L_w4r:
  s_cmp_eq_u32 s47, 0
  s_cbranch_scc0 L_w4f
  s_lshl_b32 s40, s48, 11
  s_lshl_b32 s41, s36, 8
  s_add_u32 s40, s40, s41
  s_add_u32 s40, s40, 327680
  v_lshl_add_u32 v76, v21, 4, s40
  v_lshl_add_u32 v76, v20, 14, v76
  v_add_u32 v77, 0x10000, v76
  global_store_dwordx4 v76, v[72:75], s[26:27] sc1
  global_store_dwordx4 v77, v[72:75], s[26:27] sc1
  s_branch L_w4b
L_w4f:
  s_lshl_b32 s41, s49, 7
  s_add_u32 s41, s41, 589824
  v_lshrrev_b32 v76, 3, v0
  v_mul_u32_u24 v76, 7168, v76
  v_and_b32 v77, 7, v0
  v_lshl_add_u32 v76, v77, 4, v76
  v_add_u32 v76, s41, v76
  v_add_u32 v77, 57344, v76
  global_store_dwordx4 v76, v[72:75], s[26:27] sc1
  global_store_dwordx4 v77, v[72:75], s[26:27] sc1
  s_branch L_w4b
L_roles:
  s_cmp_eq_u32 s47, 1
  s_cbranch_scc1 L_ffn
  s_cmp_eq_u32 s47, 0
  s_cbranch_scc0 L_hdone
  s_mov_b32 s40, s36
  s_mov_b32 s36, s48
  s_mov_b32 s48, s40
  s_lshl_b32 s40, s36, 2
  s_add_u32 s40, s40, s39
  s_lshl_b32 s41, s40, 17
  s_lshl_b32 s42, s48, 7
  s_add_u32 s41, s41, s42
  s_add_u32 s41, s41, 4096
  s_add_u32 s52, s12, s41
  s_addc_u32 s53, s13, 0
  v_lshlrev_b32 v58, 16, v22
  v_lshl_add_u32 v58, v20, 13, v58
  v_lshl_add_u32 v58, v23, 4, v58
  v_add_u32 v59, 0x8000, v58
  global_load_dwordx4 v[160:163], v58, s[52:53] offset:-4096 nt
  global_load_dwordx4 v[164:167], v58, s[52:53] offset:-3072 nt
  global_load_dwordx4 v[168:171], v58, s[52:53] offset:-2048 nt
  global_load_dwordx4 v[172:175], v58, s[52:53] offset:-1024 nt
  global_load_dwordx4 v[176:179], v58, s[52:53] offset:0 nt
  global_load_dwordx4 v[180:183], v58, s[52:53] offset:1024 nt
  global_load_dwordx4 v[184:187], v58, s[52:53] offset:2048 nt
  global_load_dwordx4 v[188:191], v58, s[52:53] offset:3072 nt
  s_waitcnt vmcnt(0)
  s_waitcnt vmcnt(8)
  v_perm_b32 v96, v164, v160, s44
  v_perm_b32 v97, v172, v168, s44
  v_perm_b32 v98, v180, v176, s44
  v_perm_b32 v99, v188, v184, s44
  v_perm_b32 v100, v164, v160, s45
  v_perm_b32 v101, v172, v168, s45
  v_perm_b32 v102, v180, v176, s45
  v_perm_b32 v103, v188, v184, s45
  v_perm_b32 v104, v165, v161, s44
  v_perm_b32 v105, v173, v169, s44
  v_perm_b32 v106, v181, v177, s44
  v_perm_b32 v107, v189, v185, s44
  v_perm_b32 v108, v165, v161, s45
  v_perm_b32 v109, v173, v169, s45
  v_perm_b32 v110, v181, v177, s45
  v_perm_b32 v111, v189, v185, s45
  v_perm_b32 v112, v166, v162, s44
  v_perm_b32 v113, v174, v170, s44
  v_perm_b32 v114, v182, v178, s44
  v_perm_b32 v115, v190, v186, s44
  v_perm_b32 v116, v166, v162, s45
  v_perm_b32 v117, v174, v170, s45
  v_perm_b32 v118, v182, v178, s45
  v_perm_b32 v119, v190, v186, s45
  v_perm_b32 v120, v167, v163, s44
  v_perm_b32 v121, v175, v171, s44
  v_perm_b32 v122, v183, v179, s44
  v_perm_b32 v123, v191, v187, s44
  v_perm_b32 v124, v167, v163, s45
  v_perm_b32 v125, v175, v171, s45
  v_perm_b32 v126, v183, v179, s45
  v_perm_b32 v127, v191, v187, s45
  v_and_b32 v4, 7, v0
  v_lshlrev_b32 v4, 2, v4
  s_mov_b32 s51, 262144
L_alive_w:
  global_load_dword v24, v4, s[26:27] offset:1024 sc1
  s_sub_u32 s51, s51, 1
  s_cbranch_scc1 L_alive_ok_w
  s_waitcnt vmcnt(0)
  v_cmp_ne_u32 vcc, v24, v3
  s_cbranch_vccnz L_alive_w
L_alive_ok_w:
  s_waitcnt vmcnt(0)
  s_lshl_b32 s41, s40, 13
  s_add_u32 s41, s41, 65536
  v_lshlrev_b32 v14, 4, v21
  v_lshl_add_u32 v4, v20, 11, v14
  v_add_u32 v4, s41, v4
  s_lshl_b32 s41, s36, 12
  s_lshl_b32 s42, s39, 4
  s_add_u32 s41, s41, s42
  s_add_u32 s41, s41, 983040
  v_and_b32 v8, 31, v0
  v_lshl_add_u32 v6, v8, 7, s41
  s_lshl_b32 s41, s39, 6
  s_add_u32 s41, s41, 151552
  v_lshl_add_u32 v9, v8, 1, s41
  v_lshl_add_u32 v10, v20, 4, s41
  s_lshl_b32 s41, s39, 8
  s_add_u32 s41, s41, 152064
  v_add_u32 v11, s41, v14
  v_lshlrev_b32 v12, 7, v22
  v_lshl_add_u32 v12, v20, 4, v12
  v_add_u32 v12, s41, v12
  s_lshl_b32 s41, s39, 9
  s_add_u32 s41, s41, 153600
  v_lshlrev_b32 v13, 8, v22
  v_lshl_add_u32 v13, v23, 5, v13
  v_add_u32 v13, s41, v13
  v_add_u32 v15, 153600, v14
  s_lshl_b32 s41, s36, 11
  s_lshl_b32 s42, s48, 8
  s_add_u32 s54, s41, s42
  v_mov_b32 v1, 160900
L_wo_gate0:
  s_sleep 2
  ds_read_b32 v2, v1
  s_waitcnt lgkmcnt(0)
  v_readfirstlane_b32 s40, v2
  s_cmp_lt_u32 s40, 2
  s_cbranch_scc1 L_wo_gate0
L_wo_pass:
  global_load_dwordx4 v[192:195], v59, s[52:53] offset:-4096
  global_load_dwordx4 v[196:199], v59, s[52:53] offset:-3072
  global_load_dwordx4 v[200:203], v59, s[52:53] offset:-2048
  global_load_dwordx4 v[204:207], v59, s[52:53] offset:-1024
  global_load_dwordx4 v[208:211], v59, s[52:53] offset:0
  global_load_dwordx4 v[212:215], v59, s[52:53] offset:1024
  global_load_dwordx4 v[216:219], v59, s[52:53] offset:2048
  global_load_dwordx4 v[220:223], v59, s[52:53] offset:3072
  s_mov_b32 s41, 327680
  s_add_u32 s41, s41, s54
  v_add_u32 v7, s41, v14
  v_lshrrev_b32 v5, 4, v0
  v_lshl_add_u32 v7, v5, 14, v7
  v_add_u32 v5, 0x10000, v7
  s_mov_b32 s51, 262144
L_wo_go:
  global_load_dwordx4 v[224:227], v6, s[26:27] sc1
  global_load_dwordx4 v[16:19], v4, s[26:27] offset:0 sc1
  global_load_dwordx4 v[20:23], v4, s[26:27] offset:256 sc1
  global_load_dwordx4 v[24:27], v4, s[26:27] offset:512 sc1
  global_load_dwordx4 v[28:31], v4, s[26:27] offset:768 sc1
  global_load_dwordx4 v[32:35], v4, s[26:27] offset:1024 sc1
  global_load_dwordx4 v[36:39], v4, s[26:27] offset:1280 sc1
  global_load_dwordx4 v[40:43], v4, s[26:27] offset:1536 sc1
  global_load_dwordx4 v[44:47], v4, s[26:27] offset:1792 sc1
  s_waitcnt vmcnt(9)
  v_perm_b32 v128, v196, v192, s44
  v_perm_b32 v129, v204, v200, s44
  v_perm_b32 v130, v212, v208, s44
  v_perm_b32 v131, v220, v216, s44
  v_perm_b32 v132, v196, v192, s45
  v_perm_b32 v133, v204, v200, s45
  v_perm_b32 v134, v212, v208, s45
  v_perm_b32 v135, v220, v216, s45
  v_perm_b32 v136, v197, v193, s44
  v_perm_b32 v137, v205, v201, s44
  v_perm_b32 v138, v213, v209, s44
  v_perm_b32 v139, v221, v217, s44
  v_perm_b32 v140, v197, v193, s45
  v_perm_b32 v141, v205, v201, s45
  v_perm_b32 v142, v213, v209, s45
  v_perm_b32 v143, v221, v217, s45
  v_perm_b32 v144, v198, v194, s44
  v_perm_b32 v145, v206, v202, s44
  v_perm_b32 v146, v214, v210, s44
  v_perm_b32 v147, v222, v218, s44
  v_perm_b32 v148, v198, v194, s45
  v_perm_b32 v149, v206, v202, s45
  v_perm_b32 v150, v214, v210, s45
  v_perm_b32 v151, v222, v218, s45
  v_perm_b32 v152, v199, v195, s44
  v_perm_b32 v153, v207, v203, s44
  v_perm_b32 v154, v215, v211, s44
  v_perm_b32 v155, v223, v219, s44
  v_perm_b32 v156, v199, v195, s45
  v_perm_b32 v157, v207, v203, s45
  v_perm_b32 v158, v215, v211, s45
  v_perm_b32 v159, v223, v219, s45
L_wo_poll:
  global_load_dwordx4 v[228:231], v6, s[26:27] sc1
  global_load_dwordx4 v[48:51], v4, s[26:27] offset:0 sc1
  global_load_dwordx4 v[52:55], v4, s[26:27] offset:256 sc1
  global_load_dwordx4 v[56:59], v4, s[26:27] offset:512 sc1
  global_load_dwordx4 v[60:63], v4, s[26:27] offset:768 sc1
  global_load_dwordx4 v[64:67], v4, s[26:27] offset:1024 sc1
  global_load_dwordx4 v[68:71], v4, s[26:27] offset:1280 sc1
  global_load_dwordx4 v[72:75], v4, s[26:27] offset:1536 sc1
  global_load_dwordx4 v[76:79], v4, s[26:27] offset:1792 sc1
  s_waitcnt vmcnt(9)
  v_cmp_ne_u32 s[40:41], v225, v3
  v_cmp_ne_u32 s[42:43], v227, v3
  v_max3_u32 v84, v16, v19, v22
  v_max3_u32 v85, v17, v20, v23
  v_max3_u32 v86, v18, v21, v24
  v_max3_u32 v84, v84, v25, v28
  v_max3_u32 v85, v85, v26, v29
  v_max3_u32 v86, v86, v27, v30
  v_max3_u32 v84, v84, v31, v34
  v_max3_u32 v85, v85, v32, v35
  v_max3_u32 v86, v86, v33, v36
  v_max3_u32 v84, v84, v37, v40
  v_max3_u32 v85, v85, v38, v41
  v_max3_u32 v86, v86, v39, v42
  v_max3_u32 v84, v84, v43, v46
  v_max3_u32 v85, v85, v44, v47
  v_max_u32 v86, v86, v45
  v_max3_u32 v84, v84, v85, v86
  v_cmp_eq_u32 vcc, -1, v84
  s_or_b64 s[40:41], s[40:41], s[42:43]
  s_or_b64 s[40:41], vcc, s[40:41]
  s_cbranch_scc0 L_wo_gotA
  global_load_dwordx4 v[224:227], v6, s[26:27] sc1
  global_load_dwordx4 v[16:19], v4, s[26:27] offset:0 sc1
  global_load_dwordx4 v[20:23], v4, s[26:27] offset:256 sc1
  global_load_dwordx4 v[24:27], v4, s[26:27] offset:512 sc1
  global_load_dwordx4 v[28:31], v4, s[26:27] offset:768 sc1
  global_load_dwordx4 v[32:35], v4, s[26:27] offset:1024 sc1
  global_load_dwordx4 v[36:39], v4, s[26:27] offset:1280 sc1
  global_load_dwordx4 v[40:43], v4, s[26:27] offset:1536 sc1
  global_load_dwordx4 v[44:47], v4, s[26:27] offset:1792 sc1
  s_waitcnt vmcnt(9)
  v_cmp_ne_u32 s[40:41], v229, v3
  v_cmp_ne_u32 s[42:43], v231, v3
  v_max3_u32 v84, v48, v51, v54
  v_max3_u32 v85, v49, v52, v55
  v_max3_u32 v86, v50, v53, v56
  v_max3_u32 v84, v84, v57, v60
  v_max3_u32 v85, v85, v58, v61
  v_max3_u32 v86, v86, v59, v62
  v_max3_u32 v84, v84, v63, v66
  v_max3_u32 v85, v85, v64, v67
  v_max3_u32 v86, v86, v65, v68
  v_max3_u32 v84, v84, v69, v72
  v_max3_u32 v85, v85, v70, v73
  v_max3_u32 v86, v86, v71, v74
  v_max3_u32 v84, v84, v75, v78
  v_max3_u32 v85, v85, v76, v79
  v_max_u32 v86, v86, v77
  v_max3_u32 v84, v84, v85, v86
  v_cmp_eq_u32 vcc, -1, v84
  s_or_b64 s[40:41], s[40:41], s[42:43]
  s_or_b64 s[40:41], vcc, s[40:41]
  s_cbranch_scc0 L_wo_gotB
  s_sub_u32 s51, s51, 1
  s_cbranch_scc0 L_wo_poll
L_wo_gotB:
  v_mov_b32 v84, v228
  v_perm_b32 v160, v52, v48, s44
  v_perm_b32 v161, v60, v56, s44
  v_min_f32_dpp v84, v84, v84 row_ror:8 row_mask:0xf bank_mask:0xf
  v_perm_b32 v162, v68, v64, s44
  v_perm_b32 v163, v76, v72, s44
  v_min_f32_dpp v84, v84, v84 row_ror:4 row_mask:0xf bank_mask:0xf
  v_perm_b32 v164, v52, v48, s45
  v_perm_b32 v165, v60, v56, s45
  v_min_f32_dpp v84, v84, v84 row_ror:2 row_mask:0xf bank_mask:0xf
  v_perm_b32 v166, v68, v64, s45
  v_perm_b32 v167, v76, v72, s45
  v_min_f32_dpp v84, v84, v84 row_ror:1 row_mask:0xf bank_mask:0xf
  v_mov_b32 v85, v84
  v_perm_b32 v168, v53, v49, s44
  v_perm_b32 v169, v61, v57, s44
  v_permlane16_swap_b32 v84, v85
  v_min_f32 v84, v84, v85
  v_sub_f32 v84, v84, v228
  v_exp_f32 v84, v84
  v_perm_b32 v170, v69, v65, s44
  v_cvt_pk_bf16_f32 v86, v84, v84
  ds_write_b16 v9, v86
  ds_read_b128 v[88:91], v10
  v_mul_f32 v85, v84, v230
  v_perm_b32 v171, v77, v73, s44
  v_perm_b32 v172, v53, v49, s45
  v_add_f32_dpp v85, v85, v85 row_ror:8 row_mask:0xf bank_mask:0xf
  v_perm_b32 v173, v61, v57, s45
  v_perm_b32 v174, v69, v65, s45
  v_add_f32_dpp v85, v85, v85 row_ror:4 row_mask:0xf bank_mask:0xf
  v_perm_b32 v175, v77, v73, s45
  v_perm_b32 v176, v54, v50, s44
  v_add_f32_dpp v85, v85, v85 row_ror:2 row_mask:0xf bank_mask:0xf
  v_perm_b32 v177, v62, v58, s44
  v_perm_b32 v178, v70, v66, s44
  v_add_f32_dpp v85, v85, v85 row_ror:1 row_mask:0xf bank_mask:0xf
  v_mov_b32 v86, v85
  v_perm_b32 v179, v78, v74, s44
  v_perm_b32 v180, v54, v50, s45
  v_permlane16_swap_b32 v85, v86
  v_add_f32 v85, v85, v86
  v_rcp_f32 v85, v85
  v_perm_b32 v181, v62, v58, s45
  v_perm_b32 v182, v70, v66, s45
  v_perm_b32 v183, v78, v74, s45
  v_perm_b32 v184, v55, v51, s44
  v_perm_b32 v185, v63, v59, s44
  v_perm_b32 v186, v71, v67, s44
  v_perm_b32 v187, v79, v75, s44
  v_perm_b32 v188, v55, v51, s45
  v_perm_b32 v189, v63, v59, s45
  v_perm_b32 v190, v71, v67, s45
  v_perm_b32 v191, v79, v75, s45
  s_branch L_wo_got
L_wo_gotA:
  v_mov_b32 v84, v224
  v_perm_b32 v160, v20, v16, s44
  v_perm_b32 v161, v28, v24, s44
  v_min_f32_dpp v84, v84, v84 row_ror:8 row_mask:0xf bank_mask:0xf
  v_perm_b32 v162, v36, v32, s44
  v_perm_b32 v163, v44, v40, s44
  v_min_f32_dpp v84, v84, v84 row_ror:4 row_mask:0xf bank_mask:0xf
  v_perm_b32 v164, v20, v16, s45
  v_perm_b32 v165, v28, v24, s45
  v_min_f32_dpp v84, v84, v84 row_ror:2 row_mask:0xf bank_mask:0xf
  v_perm_b32 v166, v36, v32, s45
  v_perm_b32 v167, v44, v40, s45
  v_min_f32_dpp v84, v84, v84 row_ror:1 row_mask:0xf bank_mask:0xf
  v_mov_b32 v85, v84
  v_perm_b32 v168, v21, v17, s44
  v_perm_b32 v169, v29, v25, s44
  v_permlane16_swap_b32 v84, v85
  v_min_f32 v84, v84, v85
  v_sub_f32 v84, v84, v224
  v_exp_f32 v84, v84
  v_perm_b32 v170, v37, v33, s44
  v_cvt_pk_bf16_f32 v86, v84, v84
  ds_write_b16 v9, v86
  ds_read_b128 v[88:91], v10
  v_mul_f32 v85, v84, v226
  v_perm_b32 v171, v45, v41, s44
  v_perm_b32 v172, v21, v17, s45
  v_add_f32_dpp v85, v85, v85 row_ror:8 row_mask:0xf bank_mask:0xf
  v_perm_b32 v173, v29, v25, s45
  v_perm_b32 v174, v37, v33, s45
  v_add_f32_dpp v85, v85, v85 row_ror:4 row_mask:0xf bank_mask:0xf
  v_perm_b32 v175, v45, v41, s45
  v_perm_b32 v176, v22, v18, s44
  v_add_f32_dpp v85, v85, v85 row_ror:2 row_mask:0xf bank_mask:0xf
  v_perm_b32 v177, v30, v26, s44
  v_perm_b32 v178, v38, v34, s44
  v_add_f32_dpp v85, v85, v85 row_ror:1 row_mask:0xf bank_mask:0xf
  v_mov_b32 v86, v85
  v_perm_b32 v179, v46, v42, s44
  v_perm_b32 v180, v22, v18, s45
  v_permlane16_swap_b32 v85, v86
  v_add_f32 v85, v85, v86
  v_rcp_f32 v85, v85
  v_perm_b32 v181, v30, v26, s45
  v_perm_b32 v182, v38, v34, s45
  v_perm_b32 v183, v46, v42, s45
  v_perm_b32 v184, v23, v19, s44
  v_perm_b32 v185, v31, v27, s44
  v_perm_b32 v186, v39, v35, s44
  v_perm_b32 v187, v47, v43, s44
  v_perm_b32 v188, v23, v19, s45
  v_perm_b32 v189, v31, v27, s45
  v_perm_b32 v190, v39, v35, s45
  v_perm_b32 v191, v47, v43, s45
L_wo_got:
  s_waitcnt lgkmcnt(0)
  v_mfma_f32_16x16x32_bf16 v[192:195], v[88:91], v[160:163], 0
  v_mfma_f32_16x16x32_bf16 v[196:199], v[88:91], v[164:167], 0
  v_mfma_f32_16x16x32_bf16 v[200:203], v[88:91], v[168:171], 0
  v_mfma_f32_16x16x32_bf16 v[204:207], v[88:91], v[172:175], 0
  v_mfma_f32_16x16x32_bf16 v[208:211], v[88:91], v[176:179], 0
  v_mfma_f32_16x16x32_bf16 v[212:215], v[88:91], v[180:183], 0
  v_mfma_f32_16x16x32_bf16 v[216:219], v[88:91], v[184:187], 0
  v_mfma_f32_16x16x32_bf16 v[220:223], v[88:91], v[188:191], 0
  s_nop 0
  v_mul_f32 v192, v192, v85
  v_mul_f32 v196, v196, v85
  v_mul_f32 v200, v200, v85
  v_mul_f32 v204, v204, v85
  v_mul_f32 v208, v208, v85
  v_mul_f32 v212, v212, v85
  v_mul_f32 v216, v216, v85
  v_mul_f32 v220, v220, v85
  v_cvt_pk_bf16_f32 v88, v192, v196
  v_cvt_pk_bf16_f32 v89, v200, v204
  v_cvt_pk_bf16_f32 v90, v208, v212
  v_cvt_pk_bf16_f32 v91, v216, v220
  ds_write_b128 v11, v[88:91]
  ds_read_b128 v[160:163], v12
  ds_read_b128 v[164:167], v12 offset:64
  s_waitcnt lgkmcnt(1)
  v_mfma_f32_16x16x32_bf16 v[192:195], v[160:163], v[96:99], 0
  v_mfma_f32_16x16x32_bf16 v[196:199], v[160:163], v[100:103], 0
  v_mfma_f32_16x16x32_bf16 v[200:203], v[160:163], v[104:107], 0
  v_mfma_f32_16x16x32_bf16 v[204:207], v[160:163], v[108:111], 0
  v_mfma_f32_16x16x32_bf16 v[208:211], v[160:163], v[112:115], 0
  v_mfma_f32_16x16x32_bf16 v[212:215], v[160:163], v[116:119], 0
  v_mfma_f32_16x16x32_bf16 v[216:219], v[160:163], v[120:123], 0
  v_mfma_f32_16x16x32_bf16 v[220:223], v[160:163], v[124:127], 0
  s_waitcnt lgkmcnt(0)
  v_mfma_f32_16x16x32_bf16 v[192:195], v[164:167], v[128:131], v[192:195]
  v_mfma_f32_16x16x32_bf16 v[196:199], v[164:167], v[132:135], v[196:199]
  v_mfma_f32_16x16x32_bf16 v[200:203], v[164:167], v[136:139], v[200:203]
  v_mfma_f32_16x16x32_bf16 v[204:207], v[164:167], v[140:143], v[204:207]
  v_mfma_f32_16x16x32_bf16 v[208:211], v[164:167], v[144:147], v[208:211]
  v_mfma_f32_16x16x32_bf16 v[212:215], v[164:167], v[148:151], v[212:215]
  v_mfma_f32_16x16x32_bf16 v[216:219], v[164:167], v[152:155], v[216:219]
  v_mfma_f32_16x16x32_bf16 v[220:223], v[164:167], v[156:159], v[220:223]
  s_mov_b32 exec_lo, 0xff
  s_mov_b32 exec_hi, 0xff00
  s_nop 5
  ds_write2_b32 v13, v192, v196 offset0:0 offset1:1
  ds_write2_b32 v13, v200, v204 offset0:2 offset1:3
  ds_write2_b32 v13, v208, v212 offset0:4 offset1:5
  ds_write2_b32 v13, v216, v220 offset0:6 offset1:7
  s_mov_b64 exec, -1
  s_waitcnt lgkmcnt(0)
  s_barrier
L_wo_nb:
  s_cmp_lg_u32 s39, 0
  s_cbranch_scc1 L_wo_next
  ds_read_b128 v[160:163], v15 offset:0
  ds_read_b128 v[164:167], v15 offset:256
  ds_read_b128 v[168:171], v15 offset:512
  ds_read_b128 v[172:175], v15 offset:768
  ds_read_b128 v[176:179], v15 offset:1024
  ds_read_b128 v[180:183], v15 offset:1280
  ds_read_b128 v[184:187], v15 offset:1536
  ds_read_b128 v[188:191], v15 offset:1792
  s_waitcnt lgkmcnt(6)
  v_pk_add_f32 v[160:161], v[160:161], v[164:165]
  v_pk_add_f32 v[162:163], v[162:163], v[166:167]
  s_waitcnt lgkmcnt(4)
  v_pk_add_f32 v[168:169], v[168:169], v[172:173]
  v_pk_add_f32 v[170:171], v[170:171], v[174:175]
  s_waitcnt lgkmcnt(2)
  v_pk_add_f32 v[176:177], v[176:177], v[180:181]
  v_pk_add_f32 v[178:179], v[178:179], v[182:183]
  s_waitcnt lgkmcnt(0)
  v_pk_add_f32 v[184:185], v[184:185], v[188:189]
  v_pk_add_f32 v[186:187], v[186:187], v[190:191]
  v_pk_add_f32 v[160:161], v[160:161], v[168:169]
  v_pk_add_f32 v[162:163], v[162:163], v[170:171]
  v_pk_add_f32 v[176:177], v[176:177], v[184:185]
  v_pk_add_f32 v[178:179], v[178:179], v[186:187]
  v_pk_add_f32 v[160:161], v[160:161], v[176:177]
  v_pk_add_f32 v[162:163], v[162:163], v[178:179]
  global_store_dwordx4 v7, v[160:163], s[26:27] sc1
  global_store_dwordx4 v5, v[160:163], s[26:27] sc1
L_wo_next:
  s_endpgm
L_ffn:
  v_and_b32 v8, 31, v0
  s_lshl_b32 s40, s39, 8
  v_lshl_add_u32 v5, v8, 3, s40
  global_load_dwordx2 v[48:49], v5, s[4:5]
  s_waitcnt vmcnt(0)
  v_lshlrev_b32 v50, 16, v49
  v_and_b32 v51, 0xffff0000, v49
  v_and_b32 v49, 0xffff0000, v48
  v_lshlrev_b32 v48, 16, v48
  v_and_b32 v4, 7, v0
  v_lshlrev_b32 v4, 2, v4
  s_mov_b32 s51, 262144
L_alive_f:
  global_load_dword v24, v4, s[26:27] offset:1024 sc1
  s_sub_u32 s51, s51, 1
  s_cbranch_scc1 L_alive_ok_f
  s_waitcnt vmcnt(0)
  v_cmp_ne_u32 vcc, v24, v3
  s_cbranch_vccnz L_alive_f
L_alive_ok_f:
  s_waitcnt vmcnt(0)
  v_lshrrev_b32 v9, 5, v0
  v_lshlrev_b32 v4, 11, v9
  v_lshl_add_u32 v4, v8, 4, v4
  s_lshl_b32 s40, s39, 9
  s_add_u32 s40, s40, 331776
  s_lshl_b32 s41, s48, 14
  s_add_u32 s40, s40, s41
  v_add_u32 v4, s40, v4
  v_add_u32 v6, 0x2000, v4
  v_add_u32 v5, 155648, v5
  s_lshl_b32 s40, s39, 3
  s_add_u32 s40, s40, 157184
  v_mov_b32 v7, s40
  v_mov_b32 v9, 157184
  s_lshl_b32 s40, s39, 8
  s_add_u32 s40, s40, 157696
  v_lshl_add_u32 v10, v8, 3, s40
  v_lshlrev_b32 v11, 7, v22
  v_lshl_add_u32 v11, v20, 4, v11
  v_add_u32 v11, s40, v11
  s_lshl_b32 s41, s39, 9
  s_add_u32 s41, s41, 153600
  v_lshlrev_b32 v13, 8, v22
  v_lshl_add_u32 v13, v23, 5, v13
  v_add_u32 v13, s41, v13
  v_lshlrev_b32 v14, 5, v20
  v_lshl_add_u32 v14, v23, 2, v14
  v_add_u32 v14, 153600, v14
  v_lshrrev_b32 v52, 2, v21
  v_mul_u32_u24 v52, 7168, v52
  v_and_b32 v53, 3, v21
  v_lshl_add_u32 v52, v53, 5, v52
  v_lshl_add_u32 v52, v20, 4, v52
  s_lshl_b32 s54, s49, 7
  s_mul_i32 s41, s39, 28672
  s_add_u32 s54, s54, s41
  v_cmp_eq_u32 s[56:57], 1, v20
  s_mul_i32 s41, s59, 7168
  s_add_u32 s41, s41, 592896
  v_lshl_add_u32 v53, v0, 4, s41
  v_and_b32 v54, 7, v0
  s_lshl_b32 s41, s59, 6
  v_lshl_add_u32 v54, v54, 3, s41
  v_add_u32 v55, 155648, v54
  v_lshlrev_b32 v58, 6, v22
  v_lshl_add_u32 v58, v20, 3, v58
  s_lshl_b32 s40, s39, 7
  v_add_u32 v58, s40, v58
  s_movk_i32 s40, 3584
  v_mul_u32_u24 v58, s40, v58
  v_and_b32 v59, 3, v21
  v_lshl_add_u32 v58, v59, 4, v58
  s_lshl_b32 s40, s49, 6
  v_add_u32 v58, s40, v58
  v_bfe_u32 v59, v21, 2, 1
  v_cmp_eq_u32 vcc, 1, v59
  v_mov_b32 v60, s16
  v_mov_b32 v61, s18
  v_cndmask_b32 v60, v60, v61, vcc
  v_mov_b32 v61, s17
  v_mov_b32 v62, s19
  v_cndmask_b32 v61, v61, v62, vcc
  v_mov_b32 v59, 0
  v_lshl_add_u64 v[60:61], v[58:59], 0, v[60:61]
  s_lshl_b32 s40, s49, 15
  s_lshl_b32 s41, s39, 8
  s_add_u32 s40, s40, s41
  s_add_u32 s40, s40, 4096
  s_add_u32 s52, s20, s40
  s_addc_u32 s53, s21, 0
  v_lshlrev_b32 v58, 13, v20
  v_lshl_add_u32 v58, v21, 4, v58
  v_mov_b32 v1, 160900
L_f_jit:
  s_sleep 2
  ds_read_b32 v2, v1
  s_waitcnt lgkmcnt(0)
  v_readfirstlane_b32 s40, v2
  s_cmp_lt_u32 s40, 2
  s_cbranch_scc1 L_f_jit
  s_mov_b64 s[40:41], 7168
  s_mov_b64 s[42:43], 93184
  global_load_dwordx4 v[160:163], v[60:61], off
  global_load_dwordx4 v[164:167], v[60:61], off offset:3584
  v_lshl_add_u64 v[60:61], v[60:61], 0, s[40:41]
  global_load_dwordx4 v[168:171], v[60:61], off
  global_load_dwordx4 v[172:175], v[60:61], off offset:3584
  v_lshl_add_u64 v[60:61], v[60:61], 0, s[40:41]
  global_load_dwordx4 v[176:179], v[60:61], off
  global_load_dwordx4 v[180:183], v[60:61], off offset:3584
  v_lshl_add_u64 v[60:61], v[60:61], 0, s[40:41]
  global_load_dwordx4 v[184:187], v[60:61], off
  global_load_dwordx4 v[188:191], v[60:61], off offset:3584
  v_lshl_add_u64 v[60:61], v[60:61], 0, s[42:43]
  global_load_dwordx4 v[192:195], v[60:61], off
  global_load_dwordx4 v[196:199], v[60:61], off offset:3584
  v_lshl_add_u64 v[60:61], v[60:61], 0, s[40:41]
  global_load_dwordx4 v[200:203], v[60:61], off
  global_load_dwordx4 v[204:207], v[60:61], off offset:3584
  v_lshl_add_u64 v[60:61], v[60:61], 0, s[40:41]
  global_load_dwordx4 v[208:211], v[60:61], off
  global_load_dwordx4 v[212:215], v[60:61], off offset:3584
  v_lshl_add_u64 v[60:61], v[60:61], 0, s[40:41]
  global_load_dwordx4 v[216:219], v[60:61], off
  global_load_dwordx4 v[220:223], v[60:61], off offset:3584
  global_load_dwordx4 v[224:227], v58, s[52:53] offset:-4096
  global_load_dwordx4 v[228:231], v58, s[52:53] offset:-3072
  global_load_dwordx4 v[232:235], v58, s[52:53] offset:-2048
  global_load_dwordx4 v[236:239], v58, s[52:53] offset:-1024
  global_load_dwordx4 v[240:243], v58, s[52:53] offset:0
  global_load_dwordx4 v[244:247], v58, s[52:53] offset:1024
  global_load_dwordx4 v[248:251], v58, s[52:53] offset:2048
  global_load_dwordx4 v[252:255], v58, s[52:53] offset:3072
  s_waitcnt vmcnt(16)
  v_perm_b32 v64, v164, v160, s44
  v_perm_b32 v65, v172, v168, s44
  v_perm_b32 v66, v180, v176, s44
  v_perm_b32 v67, v188, v184, s44
  v_perm_b32 v68, v164, v160, s45
  v_perm_b32 v69, v172, v168, s45
  v_perm_b32 v70, v180, v176, s45
  v_perm_b32 v71, v188, v184, s45
  v_perm_b32 v72, v165, v161, s44
  v_perm_b32 v73, v173, v169, s44
  v_perm_b32 v74, v181, v177, s44
  v_perm_b32 v75, v189, v185, s44
  v_perm_b32 v76, v165, v161, s45
  v_perm_b32 v77, v173, v169, s45
  v_perm_b32 v78, v181, v177, s45
  v_perm_b32 v79, v189, v185, s45
  v_perm_b32 v80, v166, v162, s44
  v_perm_b32 v81, v174, v170, s44
  v_perm_b32 v82, v182, v178, s44
  v_perm_b32 v83, v190, v186, s44
  v_perm_b32 v84, v166, v162, s45
  v_perm_b32 v85, v174, v170, s45
  v_perm_b32 v86, v182, v178, s45
  v_perm_b32 v87, v190, v186, s45
  v_perm_b32 v88, v167, v163, s44
  v_perm_b32 v89, v175, v171, s44
  v_perm_b32 v90, v183, v179, s44
  v_perm_b32 v91, v191, v187, s44
  v_perm_b32 v92, v167, v163, s45
  v_perm_b32 v93, v175, v171, s45
  v_perm_b32 v94, v183, v179, s45
  v_perm_b32 v95, v191, v187, s45
  s_waitcnt vmcnt(8)
  v_perm_b32 v96, v196, v192, s44
  v_perm_b32 v97, v204, v200, s44
  v_perm_b32 v98, v212, v208, s44
  v_perm_b32 v99, v220, v216, s44
  v_perm_b32 v100, v196, v192, s45
  v_perm_b32 v101, v204, v200, s45
  v_perm_b32 v102, v212, v208, s45
  v_perm_b32 v103, v220, v216, s45
  v_perm_b32 v104, v197, v193, s44
  v_perm_b32 v105, v205, v201, s44
  v_perm_b32 v106, v213, v209, s44
  v_perm_b32 v107, v221, v217, s44
  v_perm_b32 v108, v197, v193, s45
  v_perm_b32 v109, v205, v201, s45
  v_perm_b32 v110, v213, v209, s45
  v_perm_b32 v111, v221, v217, s45
  v_perm_b32 v112, v198, v194, s44
  v_perm_b32 v113, v206, v202, s44
  v_perm_b32 v114, v214, v210, s44
  v_perm_b32 v115, v222, v218, s44
  v_perm_b32 v116, v198, v194, s45
  v_perm_b32 v117, v206, v202, s45
  v_perm_b32 v118, v214, v210, s45
  v_perm_b32 v119, v222, v218, s45
  v_perm_b32 v120, v199, v195, s44
  v_perm_b32 v121, v207, v203, s44
  v_perm_b32 v122, v215, v211, s44
  v_perm_b32 v123, v223, v219, s44
  v_perm_b32 v124, v199, v195, s45
  v_perm_b32 v125, v207, v203, s45
  v_perm_b32 v126, v215, v211, s45
  v_perm_b32 v127, v223, v219, s45
  s_waitcnt vmcnt(0)
  v_perm_b32 v128, v228, v224, s44
  v_perm_b32 v129, v236, v232, s44
  v_perm_b32 v130, v244, v240, s44
  v_perm_b32 v131, v252, v248, s44
  v_perm_b32 v132, v228, v224, s45
  v_perm_b32 v133, v236, v232, s45
  v_perm_b32 v134, v244, v240, s45
  v_perm_b32 v135, v252, v248, s45
  v_perm_b32 v136, v229, v225, s44
  v_perm_b32 v137, v237, v233, s44
  v_perm_b32 v138, v245, v241, s44
  v_perm_b32 v139, v253, v249, s44
  v_perm_b32 v140, v229, v225, s45
  v_perm_b32 v141, v237, v233, s45
  v_perm_b32 v142, v245, v241, s45
  v_perm_b32 v143, v253, v249, s45
  v_perm_b32 v144, v230, v226, s44
  v_perm_b32 v145, v238, v234, s44
  v_perm_b32 v146, v246, v242, s44
  v_perm_b32 v147, v254, v250, s44
  v_perm_b32 v148, v230, v226, s45
  v_perm_b32 v149, v238, v234, s45
  v_perm_b32 v150, v246, v242, s45
  v_perm_b32 v151, v254, v250, s45
  v_perm_b32 v152, v231, v227, s44
  v_perm_b32 v153, v239, v235, s44
  v_perm_b32 v154, v247, v243, s44
  v_perm_b32 v155, v255, v251, s44
  v_perm_b32 v156, v231, v227, s45
  v_perm_b32 v157, v239, v235, s45
  v_perm_b32 v158, v247, v243, s45
  v_perm_b32 v159, v255, v251, s45
  s_lshl_b32 s40, s39, 8
  s_add_u32 s40, s40, 155648
  v_lshlrev_b32 v11, 7, v22
  v_lshl_add_u32 v11, v20, 4, v11
  v_add_u32 v11, s40, v11
  v_mov_b32 v40, 0x3f803f80
  v_mov_b32 v41, 0x3f803f80
  v_mov_b32 v42, 0x3f803f80
  v_mov_b32 v43, 0x3f803f80
  v_mov_b32 v24, -1
  v_mov_b32 v25, -1
  ds_write_b64 v7, v[24:25]
  v_mfma_f32_16x16x32_bf16 v[160:163], v[40:43], v[64:67], 0
  v_mfma_f32_16x16x32_bf16 v[164:167], v[40:43], v[68:71], 0
  v_mfma_f32_16x16x32_bf16 v[168:171], v[40:43], v[72:75], 0
  v_mfma_f32_16x16x32_bf16 v[172:175], v[40:43], v[76:79], 0
  v_mfma_f32_16x16x32_bf16 v[176:179], v[40:43], v[80:83], 0
  v_mfma_f32_16x16x32_bf16 v[180:183], v[40:43], v[84:87], 0
  v_mfma_f32_16x16x32_bf16 v[184:187], v[40:43], v[88:91], 0
  v_mfma_f32_16x16x32_bf16 v[188:191], v[40:43], v[92:95], 0
  v_mfma_f32_16x16x32_bf16 v[160:163], v[40:43], v[96:99], v[160:163]
  v_mfma_f32_16x16x32_bf16 v[164:167], v[40:43], v[100:103], v[164:167]
  v_mfma_f32_16x16x32_bf16 v[168:171], v[40:43], v[104:107], v[168:171]
  v_mfma_f32_16x16x32_bf16 v[172:175], v[40:43], v[108:111], v[172:175]
  v_mfma_f32_16x16x32_bf16 v[176:179], v[40:43], v[112:115], v[176:179]
  v_mfma_f32_16x16x32_bf16 v[180:183], v[40:43], v[116:119], v[180:183]
  v_mfma_f32_16x16x32_bf16 v[184:187], v[40:43], v[120:123], v[184:187]
  v_mfma_f32_16x16x32_bf16 v[188:191], v[40:43], v[124:127], v[188:191]
  v_add_u32 v15, 8192, v13
  v_mov_b32 v1, 160908
  v_mov_b32 v2, 1
  s_mov_b32 exec_lo, 0xff
  s_mov_b32 exec_hi, 0xff00
  s_nop 3
  ds_write2_b32 v15, v160, v164 offset0:0 offset1:1
  ds_write2_b32 v15, v168, v172 offset0:2 offset1:3
  ds_write2_b32 v15, v176, v180 offset0:4 offset1:5
  ds_write2_b32 v15, v184, v188 offset0:6 offset1:7
  s_mov_b64 exec, 1
  ds_add_u32 v1, v2
  s_mov_b64 exec, -1
L_f_cw:
  s_sleep 2
  ds_read_b32 v2, v1
  s_waitcnt lgkmcnt(0)
  v_readfirstlane_b32 s40, v2
  s_cmp_lt_u32 s40, 8
  s_cbranch_scc1 L_f_cw
  v_add_u32 v15, 8192, v14
  v_add_u32 v2, 1024, v15
  ds_read2_b32 v[24:25], v15 offset0:0 offset1:32
  ds_read2_b32 v[26:27], v15 offset0:64 offset1:96
  ds_read2_b32 v[28:29], v15 offset0:128 offset1:160
  ds_read2_b32 v[30:31], v15 offset0:192 offset1:224
  ds_read2_b32 v[32:33], v2 offset0:0 offset1:32
  ds_read2_b32 v[34:35], v2 offset0:64 offset1:96
  ds_read2_b32 v[36:37], v2 offset0:128 offset1:160
  ds_read2_b32 v[38:39], v2 offset0:192 offset1:224
  s_waitcnt lgkmcnt(0)
  v_pk_add_f32 v[24:25], v[24:25], v[26:27]
  v_pk_add_f32 v[28:29], v[28:29], v[30:31]
  v_pk_add_f32 v[32:33], v[32:33], v[34:35]
  v_pk_add_f32 v[36:37], v[36:37], v[38:39]
  v_pk_add_f32 v[24:25], v[24:25], v[28:29]
  v_pk_add_f32 v[32:33], v[32:33], v[36:37]
  v_pk_add_f32 v[58:59], v[24:25], v[32:33]
  v_add_u32 v15, 1024, v14
  v_mov_b32 v1, 160900
L_f_gate0:
  s_sleep 2
  ds_read_b32 v2, v1
  s_waitcnt lgkmcnt(0)
  v_readfirstlane_b32 s40, v2
  s_cmp_lt_u32 s40, 2
  s_cbranch_scc1 L_f_gate0
L_f_pass:
  s_mov_b32 s41, 589824
  s_add_u32 s41, s41, s54
  v_add_u32 v56, s41, v52
  s_mov_b32 s51, 262144
L_f_hint:
  global_load_dword v192, v4, s[26:27] offset:-4096 sc1
  s_waitcnt vmcnt(0)
  v_cmp_ne_u32 vcc, -1, v192
  s_sub_u32 s51, s51, 1
  s_cbranch_scc1 L_f_go
  s_cbranch_vccz L_f_hint
L_f_go:
  global_load_dwordx4 v[192:195], v4, s[26:27] offset:-4096 sc1
  global_load_dwordx4 v[196:199], v4, s[26:27] offset:0 sc1
  global_load_dwordx4 v[200:203], v6, s[26:27] offset:-4096 sc1
  global_load_dwordx4 v[204:207], v6, s[26:27] offset:0 sc1
  s_sleep 3
L_f_poll:
  global_load_dwordx4 v[208:211], v4, s[26:27] offset:-4096 sc1
  global_load_dwordx4 v[212:215], v4, s[26:27] offset:0 sc1
  global_load_dwordx4 v[216:219], v6, s[26:27] offset:-4096 sc1
  global_load_dwordx4 v[220:223], v6, s[26:27] offset:0 sc1
  s_waitcnt vmcnt(4)
  v_max3_u32 v40, v192, v195, v198
  v_max3_u32 v41, v193, v196, v199
  v_max3_u32 v42, v194, v197, v200
  v_max3_u32 v40, v40, v201, v204
  v_max3_u32 v41, v41, v202, v205
  v_max3_u32 v42, v42, v203, v206
  v_max_u32 v40, v40, v207
  v_max3_u32 v40, v40, v41, v42
  v_cmp_eq_u32 vcc, -1, v40
  s_cbranch_vccz L_f_gotA
  global_load_dwordx4 v[192:195], v4, s[26:27] offset:-4096 sc1
  global_load_dwordx4 v[196:199], v4, s[26:27] offset:0 sc1
  global_load_dwordx4 v[200:203], v6, s[26:27] offset:-4096 sc1
  global_load_dwordx4 v[204:207], v6, s[26:27] offset:0 sc1
  s_waitcnt vmcnt(4)
  v_max3_u32 v40, v208, v211, v214
  v_max3_u32 v41, v209, v212, v215
  v_max3_u32 v42, v210, v213, v216
  v_max3_u32 v40, v40, v217, v220
  v_max3_u32 v41, v41, v218, v221
  v_max3_u32 v42, v42, v219, v222
  v_max_u32 v40, v40, v223
  v_max3_u32 v40, v40, v41, v42
  v_cmp_eq_u32 vcc, -1, v40
  s_sub_u32 s51, s51, 1
  s_cbranch_scc1 L_f_gotB
  s_cbranch_vccnz L_f_poll
L_f_gotB:
  v_pk_add_f32 v[40:41], v[208:209], v[212:213]
  v_pk_add_f32 v[42:43], v[210:211], v[214:215]
  v_pk_add_f32 v[44:45], v[216:217], v[220:221]
  v_pk_add_f32 v[46:47], v[218:219], v[222:223]
  s_branch L_f_got
L_f_gotA:
  v_pk_add_f32 v[40:41], v[192:193], v[196:197]
  v_pk_add_f32 v[42:43], v[194:195], v[198:199]
  v_pk_add_f32 v[44:45], v[200:201], v[204:205]
  v_pk_add_f32 v[46:47], v[202:203], v[206:207]
L_f_got:
  v_pk_add_f32 v[24:25], v[40:41], v[44:45]
  v_pk_add_f32 v[26:27], v[42:43], v[46:47]
  v_mov_b32 v28, v24
  v_mov_b32 v29, v25
  v_mov_b32 v30, v26
  v_mov_b32 v31, v27
  s_nop 1
  v_permlane32_swap_b32 v24, v28
  v_permlane32_swap_b32 v25, v29
  v_permlane32_swap_b32 v26, v30
  v_permlane32_swap_b32 v27, v31
  v_add_f32 v24, v24, v28
  v_add_f32 v25, v25, v29
  v_add_f32 v26, v26, v30
  v_add_f32 v27, v27, v31
  v_cvt_pk_bf16_f32 v28, v24, v25
  v_cvt_pk_bf16_f32 v29, v26, v27
  v_lshlrev_b32 v24, 16, v28
  v_and_b32 v25, 0xffff0000, v28
  v_lshlrev_b32 v26, 16, v29
  v_and_b32 v27, 0xffff0000, v29
  v_pk_add_f32 v[24:25], v[24:25], v[48:49]
  v_pk_add_f32 v[26:27], v[26:27], v[50:51]
  v_cvt_pk_bf16_f32 v28, v24, v25
  v_cvt_pk_bf16_f32 v29, v26, v27
  ds_write_b64 v5, v[28:29]
  ds_read_b128 v[40:43], v11
  ds_read_b128 v[44:47], v11 offset:64
  v_lshlrev_b32 v24, 16, v28
  v_and_b32 v25, 0xffff0000, v28
  v_lshlrev_b32 v26, 16, v29
  v_and_b32 v27, 0xffff0000, v29
  v_readfirstlane_b32 s40, v24
  s_nop 1
  v_subrev_f32 v32, s40, v24
  v_subrev_f32 v33, s40, v25
  v_subrev_f32 v34, s40, v26
  v_subrev_f32 v35, s40, v27
  v_add_f32 v30, v32, v33
  v_mul_f32 v31, v32, v32
  v_add_f32 v36, v34, v35
  v_mul_f32 v37, v33, v33
  v_fmac_f32 v31, v34, v34
  v_fmac_f32 v37, v35, v35
  v_add_f32 v30, v30, v36
  v_add_f32 v31, v31, v37
  s_waitcnt lgkmcnt(0)
  v_mfma_f32_16x16x32_bf16 v[160:163], v[40:43], v[64:67], 0
  v_add_f32_dpp v30, v30, v30 row_ror:8 row_mask:0xf bank_mask:0xf
  v_add_f32_dpp v31, v31, v31 row_ror:8 row_mask:0xf bank_mask:0xf
  v_mfma_f32_16x16x32_bf16 v[164:167], v[40:43], v[68:71], 0
  v_add_f32_dpp v30, v30, v30 row_ror:4 row_mask:0xf bank_mask:0xf
  v_add_f32_dpp v31, v31, v31 row_ror:4 row_mask:0xf bank_mask:0xf
  v_mfma_f32_16x16x32_bf16 v[168:171], v[40:43], v[72:75], 0
  v_add_f32_dpp v30, v30, v30 row_ror:2 row_mask:0xf bank_mask:0xf
  v_add_f32_dpp v31, v31, v31 row_ror:2 row_mask:0xf bank_mask:0xf
  v_mfma_f32_16x16x32_bf16 v[172:175], v[40:43], v[76:79], 0
  v_add_f32_dpp v30, v30, v30 row_ror:1 row_mask:0xf bank_mask:0xf
  v_add_f32_dpp v31, v31, v31 row_ror:1 row_mask:0xf bank_mask:0xf
  v_mfma_f32_16x16x32_bf16 v[176:179], v[40:43], v[80:83], 0
  v_mov_b32 v32, v30
  v_mov_b32 v33, v31
  v_mfma_f32_16x16x32_bf16 v[180:183], v[40:43], v[84:87], 0
  v_mfma_f32_16x16x32_bf16 v[184:187], v[40:43], v[88:91], 0
  v_permlane16_swap_b32 v30, v32
  v_permlane16_swap_b32 v31, v33
  v_mfma_f32_16x16x32_bf16 v[188:191], v[40:43], v[92:95], 0
  v_add_f32 v30, v30, v32
  v_add_f32 v31, v31, v33
  v_mfma_f32_16x16x32_bf16 v[160:163], v[44:47], v[96:99], v[160:163]
  v_mul_f32 v32, 0x3c000000, v30
  v_mfma_f32_16x16x32_bf16 v[164:167], v[44:47], v[100:103], v[164:167]
  v_fma_f32 v31, -v32, v30, v31
  v_add_f32 v30, s40, v32
  v_mfma_f32_16x16x32_bf16 v[168:171], v[44:47], v[104:107], v[168:171]
  v_min_u32 v31, -2, v31
  v_mfma_f32_16x16x32_bf16 v[172:175], v[44:47], v[108:111], v[172:175]
  ds_write_b64 v7, v[30:31]
  v_mfma_f32_16x16x32_bf16 v[176:179], v[44:47], v[112:115], v[176:179]
  v_mfma_f32_16x16x32_bf16 v[180:183], v[44:47], v[116:119], v[180:183]
  v_mfma_f32_16x16x32_bf16 v[184:187], v[44:47], v[120:123], v[184:187]
  v_mfma_f32_16x16x32_bf16 v[188:191], v[44:47], v[124:127], v[188:191]
  ds_read_b128 v[32:35], v9
  ds_read_b128 v[36:39], v9 offset:16
  s_mov_b32 exec_lo, 0xff
  s_mov_b32 exec_hi, 0xff00
  s_nop 3
  ds_write2_b32 v13, v160, v164 offset0:0 offset1:1
  ds_write2_b32 v13, v168, v172 offset0:2 offset1:3
  ds_write2_b32 v13, v176, v180 offset0:4 offset1:5
  ds_write2_b32 v13, v184, v188 offset0:6 offset1:7
  s_mov_b64 exec, -1
  s_waitcnt lgkmcnt(4)
L_f_ck:
  v_max3_u32 v30, v33, v35, v37
  v_add_f32 v24, v32, v34
  v_max_u32 v30, v30, v39
  v_add_f32 v31, v36, v38
  v_cmp_eq_u32 vcc, -1, v30
  v_add_f32 v30, v24, v31
  s_cbranch_vccz L_f_sok
  ds_read_b128 v[32:35], v9
  ds_read_b128 v[36:39], v9 offset:16
  s_waitcnt lgkmcnt(0)
  s_branch L_f_ck
L_f_sok:
  v_add_f32 v33, v33, v35
  v_mul_f32 v30, 0x3e800000, v30
  v_add_f32 v37, v37, v39
  v_sub_f32 v32, v32, v30
  v_sub_f32 v34, v34, v30
  v_sub_f32 v36, v36, v30
  v_sub_f32 v38, v38, v30
  v_add_f32 v33, v33, v37
  s_waitcnt lgkmcnt(0)
  s_barrier
  ds_read2_b32 v[160:161], v14 offset0:0 offset1:32
  ds_read2_b32 v[162:163], v14 offset0:64 offset1:96
  ds_read2_b32 v[164:165], v14 offset0:128 offset1:160
  ds_read2_b32 v[166:167], v14 offset0:192 offset1:224
  ds_read2_b32 v[168:169], v15 offset0:0 offset1:32
  ds_read2_b32 v[170:171], v15 offset0:64 offset1:96
  ds_read2_b32 v[172:173], v15 offset0:128 offset1:160
  ds_read2_b32 v[174:175], v15 offset0:192 offset1:224
  v_mul_f32 v32, v32, v32
  v_mul_f32 v36, v36, v36
  v_fmac_f32 v32, v34, v34
  v_fmac_f32 v36, v38, v38
  v_add_f32 v32, v32, v36
  v_mul_f32 v33, 0x3b000000, v33
  v_cvt_pk_bf16_f32 v30, v30, v30
  v_fmac_f32 v33, 0x3e800000, v32
  v_and_b32 v30, 0xffff0000, v30
  v_cvt_pk_bf16_f32 v33, v33, v33
  v_and_b32 v33, 0xffff0000, v33
  v_add_f32 v33, 0x3727c5ac, v33
  v_cvt_pk_bf16_f32 v33, v33, v33
  v_and_b32 v33, 0xffff0000, v33
  v_sqrt_f32 v33, v33
  s_waitcnt lgkmcnt(6)
  v_pk_add_f32 v[160:161], v[160:161], v[162:163]
  v_cvt_pk_bf16_f32 v33, v33, v33
  s_waitcnt lgkmcnt(4)
  v_pk_add_f32 v[164:165], v[164:165], v[166:167]
  v_and_b32 v33, 0xffff0000, v33
  s_waitcnt lgkmcnt(2)
  v_pk_add_f32 v[168:169], v[168:169], v[170:171]
  v_rcp_f32 v32, v33
  s_waitcnt lgkmcnt(0)
  v_pk_add_f32 v[172:173], v[172:173], v[174:175]
  v_pk_add_f32 v[160:161], v[160:161], v[164:165]
  v_pk_add_f32 v[168:169], v[168:169], v[172:173]
  v_pk_fma_f32 v[160:161], v[58:59], v[30:31], v[160:161] op_sel_hi:[1,0,1] neg_lo:[0,1,0] neg_hi:[0,1,0]
  v_pk_add_f32 v[24:25], v[160:161], v[168:169]
  v_pk_mul_f32 v[24:25], v[24:25], v[32:33] op_sel_hi:[1,0]
  v_cvt_pk_bf16_f32 v26, v24, v25
  v_lshlrev_b32 v24, 16, v26
  v_and_b32 v25, 0xffff0000, v26
  v_mul_f32 v26, 0xbfb8aa3b, v24
  v_exp_f32 v26, v26
  s_nop 0
  v_add_f32 v26, 1.0, v26
  v_rcp_f32 v26, v26
  s_nop 0
  v_mul_f32 v26, v24, v26
  v_cvt_pk_bf16_f32 v26, v26, v26
  v_and_b32 v26, 0xffff0000, v26
  v_mul_f32 v26, v26, v25
  s_nop 1
  v_mov_b32_dpp v27, v26 quad_perm:[1,0,3,2] row_mask:0xf bank_mask:0xf
  v_cvt_pk_bf16_f32 v26, v26, v27
  s_nop 1
  v_mov_b32_dpp v40, v26 row_newbcast:0 row_mask:0xf bank_mask:0xf
  v_mov_b32_dpp v41, v26 row_newbcast:2 row_mask:0xf bank_mask:0xf
  v_mov_b32_dpp v42, v26 row_newbcast:4 row_mask:0xf bank_mask:0xf
  v_mov_b32_dpp v43, v26 row_newbcast:6 row_mask:0xf bank_mask:0xf
  s_nop 1
  v_mfma_f32_16x16x32_bf16 v[160:163], v[40:43], v[128:131], 0
  v_mfma_f32_16x16x32_bf16 v[164:167], v[40:43], v[132:135], 0
  v_mfma_f32_16x16x32_bf16 v[168:171], v[40:43], v[136:139], 0
  v_mfma_f32_16x16x32_bf16 v[172:175], v[40:43], v[140:143], 0
  v_mfma_f32_16x16x32_bf16 v[176:179], v[40:43], v[144:147], 0
  v_mfma_f32_16x16x32_bf16 v[180:183], v[40:43], v[148:151], 0
  v_mfma_f32_16x16x32_bf16 v[184:187], v[40:43], v[152:155], 0
  v_mfma_f32_16x16x32_bf16 v[188:191], v[40:43], v[156:159], 0
  s_nop 4
  v_cndmask_b32 v24, v160, v176, s[56:57]
  v_cndmask_b32 v25, v164, v180, s[56:57]
  v_cndmask_b32 v26, v168, v184, s[56:57]
  v_cndmask_b32 v27, v172, v188, s[56:57]
  s_mov_b32 exec_hi, 0
  global_store_dwordx4 v56, v[24:27], s[26:27] sc1
  s_mov_b64 exec, -1
  s_cmp_eq_u32 s39, 0
  s_cbranch_scc1 L_f_fin
  s_cmp_lg_u32 s39, 1
  s_cbranch_scc1 L_f_next
  s_cmp_lg_u32 s59, 0
  s_cbranch_scc1 L_f_next
  v_mov_b32 v57, 0
  s_mov_b64 exec, 1
  global_store_dword v57, v3, s[26:27] sc1
  s_mov_b64 exec, -1
  s_branch L_f_next
L_f_fin:
  s_cmp_ge_u32 s59, 16
  s_cbranch_scc1 L_f_next
  s_waitcnt vmcnt(1)
  global_load_dwordx4 v[192:195], v53, s[26:27] offset:-3072 sc1
  global_load_dwordx4 v[196:199], v53, s[26:27] offset:-2048 sc1
  global_load_dwordx4 v[200:203], v53, s[26:27] offset:-1024 sc1
  global_load_dwordx4 v[204:207], v53, s[26:27] offset:0 sc1
  global_load_dwordx4 v[208:211], v53, s[26:27] offset:1024 sc1
  global_load_dwordx4 v[212:215], v53, s[26:27] offset:2048 sc1
  global_load_dwordx4 v[216:219], v53, s[26:27] offset:3072 sc1
  s_mov_b64 s[42:43], s[22:23]
  ds_read_b64 v[44:45], v55
  s_mov_b32 s51, 262144
  s_sleep 3
L_o_poll:
  global_load_dwordx4 v[220:223], v53, s[26:27] offset:-3072 sc1
  global_load_dwordx4 v[224:227], v53, s[26:27] offset:-2048 sc1
  global_load_dwordx4 v[228:231], v53, s[26:27] offset:-1024 sc1
  global_load_dwordx4 v[232:235], v53, s[26:27] offset:0 sc1
  global_load_dwordx4 v[236:239], v53, s[26:27] offset:1024 sc1
  global_load_dwordx4 v[240:243], v53, s[26:27] offset:2048 sc1
  global_load_dwordx4 v[244:247], v53, s[26:27] offset:3072 sc1
  s_waitcnt vmcnt(7)
  v_max3_u32 v40, v192, v195, v198
  v_max3_u32 v41, v193, v196, v199
  v_max3_u32 v42, v194, v197, v200
  v_max3_u32 v40, v40, v201, v204
  v_max3_u32 v41, v41, v202, v205
  v_max3_u32 v42, v42, v203, v206
  v_max3_u32 v40, v40, v207, v210
  v_max3_u32 v41, v41, v208, v211
  v_max3_u32 v42, v42, v209, v212
  v_max3_u32 v40, v40, v213, v216
  v_max3_u32 v41, v41, v214, v217
  v_max3_u32 v42, v42, v215, v218
  v_max_u32 v40, v40, v219
  v_max3_u32 v40, v40, v41, v42
  v_cmp_eq_u32 vcc, -1, v40
  s_cbranch_vccz L_o_gotA
  global_load_dwordx4 v[192:195], v53, s[26:27] offset:-3072 sc1
  global_load_dwordx4 v[196:199], v53, s[26:27] offset:-2048 sc1
  global_load_dwordx4 v[200:203], v53, s[26:27] offset:-1024 sc1
  global_load_dwordx4 v[204:207], v53, s[26:27] offset:0 sc1
  global_load_dwordx4 v[208:211], v53, s[26:27] offset:1024 sc1
  global_load_dwordx4 v[212:215], v53, s[26:27] offset:2048 sc1
  global_load_dwordx4 v[216:219], v53, s[26:27] offset:3072 sc1
  s_waitcnt vmcnt(7)
  v_max3_u32 v40, v220, v223, v226
  v_max3_u32 v41, v221, v224, v227
  v_max3_u32 v42, v222, v225, v228
  v_max3_u32 v40, v40, v229, v232
  v_max3_u32 v41, v41, v230, v233
  v_max3_u32 v42, v42, v231, v234
  v_max3_u32 v40, v40, v235, v238
  v_max3_u32 v41, v41, v236, v239
  v_max3_u32 v42, v42, v237, v240
  v_max3_u32 v40, v40, v241, v244
  v_max3_u32 v41, v41, v242, v245
  v_max3_u32 v42, v42, v243, v246
  v_max_u32 v40, v40, v247
  v_max3_u32 v40, v40, v41, v42
  v_cmp_eq_u32 vcc, -1, v40
  s_sub_u32 s51, s51, 1
  s_cbranch_scc1 L_o_gotB
  s_cbranch_vccnz L_o_poll
L_o_gotB:
  v_pk_add_f32 v[160:161], v[220:221], v[224:225]
  v_pk_add_f32 v[162:163], v[222:223], v[226:227]
  v_pk_add_f32 v[164:165], v[228:229], v[232:233]
  v_pk_add_f32 v[166:167], v[230:231], v[234:235]
  v_pk_add_f32 v[168:169], v[236:237], v[240:241]
  v_pk_add_f32 v[170:171], v[238:239], v[242:243]
  v_pk_add_f32 v[160:161], v[160:161], v[244:245]
  v_pk_add_f32 v[162:163], v[162:163], v[246:247]
  s_branch L_o_got
L_o_gotA:
  v_pk_add_f32 v[160:161], v[192:193], v[196:197]
  v_pk_add_f32 v[162:163], v[194:195], v[198:199]
  v_pk_add_f32 v[164:165], v[200:201], v[204:205]
  v_pk_add_f32 v[166:167], v[202:203], v[206:207]
  v_pk_add_f32 v[168:169], v[208:209], v[212:213]
  v_pk_add_f32 v[170:171], v[210:211], v[214:215]
  v_pk_add_f32 v[160:161], v[160:161], v[216:217]
  v_pk_add_f32 v[162:163], v[162:163], v[218:219]
L_o_got:
  v_pk_add_f32 v[164:165], v[164:165], v[168:169]
  v_pk_add_f32 v[166:167], v[166:167], v[170:171]
  v_pk_add_f32 v[160:161], v[160:161], v[164:165]
  v_pk_add_f32 v[162:163], v[162:163], v[166:167]
  s_nop 0
  v_add_f32_dpp v160, v160, v160 row_ror:8 row_mask:0xf bank_mask:0xf
  v_add_f32_dpp v161, v161, v161 row_ror:8 row_mask:0xf bank_mask:0xf
  v_add_f32_dpp v162, v162, v162 row_ror:8 row_mask:0xf bank_mask:0xf
  v_add_f32_dpp v163, v163, v163 row_ror:8 row_mask:0xf bank_mask:0xf
  v_mov_b32 v164, v160
  v_mov_b32 v165, v161
  v_mov_b32 v166, v162
  v_mov_b32 v167, v163
  s_nop 1
  v_permlane16_swap_b32 v160, v164
  v_permlane16_swap_b32 v161, v165
  v_permlane16_swap_b32 v162, v166
  v_permlane16_swap_b32 v163, v167
  v_add_f32 v160, v160, v164
  v_add_f32 v161, v161, v165
  v_add_f32 v162, v162, v166
  v_add_f32 v163, v163, v167
  v_mov_b32 v164, v160
  v_mov_b32 v165, v161
  v_mov_b32 v166, v162
  v_mov_b32 v167, v163
  s_nop 1
  v_permlane32_swap_b32 v160, v164
  v_permlane32_swap_b32 v161, v165
  v_permlane32_swap_b32 v162, v166
  v_permlane32_swap_b32 v163, v167
  v_add_f32 v160, v160, v164
  v_add_f32 v161, v161, v165
  v_add_f32 v162, v162, v166
  v_add_f32 v163, v163, v167
  v_cvt_pk_bf16_f32 v164, v160, v161
  v_cvt_pk_bf16_f32 v165, v162, v163
  v_lshlrev_b32 v160, 16, v164
  v_and_b32 v161, 0xffff0000, v164
  v_lshlrev_b32 v162, 16, v165
  v_and_b32 v163, 0xffff0000, v165
  s_waitcnt lgkmcnt(0)
  v_lshlrev_b32 v164, 16, v44
  v_and_b32 v165, 0xffff0000, v44
  v_lshlrev_b32 v166, 16, v45
  v_and_b32 v167, 0xffff0000, v45
  v_pk_add_f32 v[160:161], v[160:161], v[164:165]
  v_pk_add_f32 v[162:163], v[162:163], v[166:167]
  v_cvt_pk_bf16_f32 v160, v160, v161
  v_cvt_pk_bf16_f32 v161, v162, v163
  s_mov_b64 exec, 0xff
  global_store_dwordx2 v54, v[160:161], s[42:43] sc1
  s_mov_b64 exec, -1
L_f_next:
L_hdone:
L_end:
  s_endpgm
.section .rodata,"a"
.p2align 6
.amdhsa_kernel sequential_preLN__gqa_block_cached__glu_gated_swiglu__decode_kernel
  .amdhsa_next_free_vgpr 256
  .amdhsa_next_free_sgpr 96
  .amdhsa_accum_offset 256
  .amdhsa_group_segment_fixed_size 0
  .amdhsa_kernarg_size 96
  .amdhsa_user_sgpr_count 2
  .amdhsa_user_sgpr_kernarg_segment_ptr 1
  .amdhsa_system_sgpr_workgroup_id_x 1
  .amdhsa_float_denorm_mode_32 3
.end_amdhsa_kernel
```
